```python
import torch

def _softmax(x, axis=-1):
    return torch.softmax(x, dim=axis)
def _gelu(x):
    return torch.nn.functional.gelu(x, approximate="tanh")
def _silu(x):
    return torch.nn.functional.silu(x)
def _sigmoid(x):
    return torch.sigmoid(x)
def _layernorm(x, axis=-1, eps=1e-5):
    m = x.mean(dim=axis, keepdim=True)
    v = x.var(dim=axis, keepdim=True, unbiased=False)
    return (x - m) / torch.sqrt(v + eps)
def _scatter_add(tgt, idx, src, axis=0):
    return tgt.clone().index_add_(axis, idx, src)
def _segment_sum(src, seg, n):
    out = torch.zeros((n,) + src.shape[1:], dtype=src.dtype)
    return out.index_add_(0, seg, src)
def _pad(x, pw):
    flat = tuple(v for pair in reversed(pw) for v in pair)
    return torch.nn.functional.pad(x, flat)

kernel_name = 'sequential_preLN__softmax_full_mha__geglu_ffn__prompt'

def setup_inputs():

    _w = (lambda a: (lambda t: t.to(torch.bfloat16) if t.is_floating_point() else t)(torch.as_tensor(a)))
    def _A_setup():
        B, S, D = 1, 2048, 512
        return {
            "x": _w((lambda *s: torch.randn(*s, dtype=torch.bfloat16) * 0.05)(B, S, D)),
            "wqkv": _w((lambda *s: torch.randn(*s, dtype=torch.bfloat16) * 0.05)(D, 3 * D)),
            "wo": _w((lambda *s: torch.randn(*s, dtype=torch.bfloat16) * 0.05)(D, D)),
        }
    _A_in = _A_setup()

    def _B_setup():
        B, S, D, F = 1, 2048, 512, 1792
        return {
            "x": _w((lambda *s: torch.randn(*s, dtype=torch.bfloat16) * 0.05)(B, S, D)),
            "w_gate": _w((lambda *s: torch.randn(*s, dtype=torch.bfloat16) * 0.05)(D, F)),
            "w_up": _w((lambda *s: torch.randn(*s, dtype=torch.bfloat16) * 0.05)(D, F)),
            "w_down": _w((lambda *s: torch.randn(*s, dtype=torch.bfloat16) * 0.05)(F, D)),
        }
    _B_in = _B_setup()

    return {
        "A_x": _A_in["x"],
        "A_wqkv": _A_in["wqkv"],
        "A_wo": _A_in["wo"],
        "B_x": _B_in["x"],
        "B_w_gate": _B_in["w_gate"],
        "B_w_up": _B_in["w_up"],
        "B_w_down": _B_in["w_down"],
    }

def reference(A_x, A_wqkv, A_wo, B_x, B_w_gate, B_w_up, B_w_down):
    def _A_ref(x, wqkv, wo):
        B, S, D = x.shape
        H = 32; Dh = D // H
        qkv = (lambda x, *d: x.permute(*d))((x @ wqkv).reshape(B, S, 3, H, Dh), 2, 0, 3, 1, 4)
        q, k, v = qkv[0], qkv[1], qkv[2]
        scale = Dh ** -0.5
        scores = torch.einsum("bhqd,bhkd->bhqk", q, k) * scale
        p = _softmax(scores, axis=-1)
        o = torch.einsum("bhqk,bhkd->bhqd", p, v)
        return (lambda x, *d: x.permute(*d))(o, 0, 2, 1, 3).reshape(B, S, D) @ wo

    def _B_ref(x, w_gate, w_up, w_down):
        return (_gelu(x @ w_gate) * (x @ w_up)) @ w_down

    x = A_x
    h = x + _A_ref(_layernorm(x, axis=-1), A_wqkv, A_wo)
    h2 = h + _B_ref(_layernorm(h, axis=-1), B_w_gate, B_w_up, B_w_down)
    return h2
```

```asm
; @launch kernel=qkv_kernel grid=(256,1,1) block=(768,1,1) lds=163840
; @launch kernel=fused_kernel grid=(256,1,1) block=(512,1,1) lds=163840
.amdgcn_target "amdgcn-amd-amdhsa--gfx950"
.text
.globl qkv_kernel
.p2align 8
.type qkv_kernel,@function
qkv_kernel:
    s_cmp_ge_u32 s2, 256
    s_cbranch_scc1 qkv_end
    s_load_dwordx4 s[4:7], s[0:1], 0
    s_load_dwordx2 s[8:9], s[0:1], 72
    v_lshrrev_b32 v2, 6, v0
    v_and_b32 v1, 63, v0
    v_readfirstlane_b32 s24, v2
    s_and_b32 s25, s2, 7
    s_lshr_b32 s26, s2, 3
    s_lshr_b32 s29, s26, 2
    s_and_b32 s30, s26, 3
    s_and_b32 s27, s25, 1
    s_lshl_b32 s27, s27, 2
    s_add_u32 s27, s27, s30
    s_lshl_b32 s31, s29, 0
    s_and_b32 s31, s31, 7
    s_cmp_ge_u32 s24, 8
    s_cbranch_scc1 qkv_ld
qkv_x:
    s_lshr_b32 s28, s25, 1
    s_lshl_b32 s28, s28, 3
    s_add_u32 s28, s28, s29
    v_lshrrev_b32 v2, 3, v1
    v_and_b32 v3, 7, v1
    v_lshlrev_b32 v4, 4, v3
    v_lshl_add_u32 v10, v2, 10, v4
    s_lshl_b32 s32, s28, 3
    s_add_u32 s32, s32, s24
    s_lshl_b32 s32, s32, 13
    s_waitcnt lgkmcnt(0)
    s_mov_b32 s12, s4
    s_and_b32 s13, s5, 0xffff
    s_mov_b32 s14, 2097152
    s_mov_b32 s15, 0x20000
    buffer_load_dwordx4 v[12:15], v10, s[12:15], s32 offen offset:0
    buffer_load_dwordx4 v[16:19], v10, s[12:15], s32 offen offset:128
    buffer_load_dwordx4 v[20:23], v10, s[12:15], s32 offen offset:256
    buffer_load_dwordx4 v[24:27], v10, s[12:15], s32 offen offset:384
    buffer_load_dwordx4 v[28:31], v10, s[12:15], s32 offen offset:512
    buffer_load_dwordx4 v[32:35], v10, s[12:15], s32 offen offset:640
    buffer_load_dwordx4 v[36:39], v10, s[12:15], s32 offen offset:768
    buffer_load_dwordx4 v[40:43], v10, s[12:15], s32 offen offset:896
    s_mov_b32 s20, s8
    s_and_b32 s21, s9, 0xffff
    s_mov_b32 s22, 18219008
    s_mov_b32 s23, 0x20000
    s_lshl_b32 s33, s24, 3
    s_and_b32 s33, s33, 31
    v_add_u32 v2, s33, v2
    v_xor_b32 v2, v2, v3
    v_lshlrev_b32 v2, 4, v2
    v_lshl_add_u32 v2, v3, 9, v2
    s_lshr_b32 s33, s24, 2
    s_lshl_b32 s33, s33, 15
    v_add_u32 v11, s33, v2
    s_and_b32 s29, s24, 1
    s_bfe_u32 s30, s24, 0x10001
    v_and_b32 v2, 31, v1
    v_lshrrev_b32 v3, 5, v1
    v_xor_b32 v2, v2, v3
    v_lshlrev_b32 v2, 4, v2
    v_lshl_add_u32 v2, v3, 9, v2
    s_lshl_b32 s35, s29, 15
    v_add_u32 v6, s35, v2
    v_xor_b32 v7, 1056, v6
    v_xor_b32 v8, 2112, v6
    v_xor_b32 v9, 3168, v6
    v_bfe_u32 v2, v1, 2, 2
    v_lshl_add_u32 v4, v3, 3, v2
    v_mul_u32_u24 v4, 384, v4
    v_lshrrev_b32 v2, 1, v2
    v_xor_b32 v2, s30, v2
    v_lshl_add_u32 v4, v2, 6, v4
    v_bfe_u32 v2, v1, 4, 1
    v_lshl_add_u32 v4, v2, 5, v4
    v_and_b32 v2, 3, v1
    v_lshl_add_u32 v4, v2, 3, v4
    v_add_u32 v48, 65536, v4
    v_mov_b32 v76, 0
    v_mov_b32 v77, 0
    v_mov_b32 v78, 0
    v_mov_b32 v79, 0
    v_mov_b32 v80, 0
    v_mov_b32 v81, 0
    v_mov_b32 v82, 0
    v_mov_b32 v83, 0
    v_mov_b32 v84, 0
    v_mov_b32 v85, 0
    v_mov_b32 v86, 0
    v_mov_b32 v87, 0
    v_mov_b32 v88, 0
    v_mov_b32 v89, 0
    v_mov_b32 v90, 0
    v_mov_b32 v91, 0
    v_mov_b32 v92, 0
    v_mov_b32 v93, 0
    v_mov_b32 v94, 0
    v_mov_b32 v95, 0
    v_mov_b32 v96, 0
    v_mov_b32 v97, 0
    v_mov_b32 v98, 0
    v_mov_b32 v99, 0
    v_mov_b32 v100, 0
    v_mov_b32 v101, 0
    v_mov_b32 v102, 0
    v_mov_b32 v103, 0
    v_mov_b32 v104, 0
    v_mov_b32 v105, 0
    v_mov_b32 v106, 0
    v_mov_b32 v107, 0
    v_mov_b32 v56, 0
    v_mov_b32 v57, 0
    v_mov_b32 v58, 0
    v_mov_b32 v59, 0
    v_mov_b32 v68, 0
    v_mov_b32 v69, 0
    v_mov_b32 v70, 0
    v_mov_b32 v71, 0
    v_mov_b32 v72, 0
    v_mov_b32 v73, 0
    v_mov_b32 v74, 0
    v_mov_b32 v75, 0
    v_mov_b32 v108, 0x3f803f80
    v_mov_b32 v109, 0
    v_mov_b32 v110, 0
    v_mov_b32 v112, 0
    v_mov_b32 v113, 0
    s_waitcnt vmcnt(7)
    v_dot2c_f32_bf16 v109, v12, v108
    v_dot2c_f32_bf16 v112, v12, v12
    v_dot2c_f32_bf16 v110, v13, v108
    v_dot2c_f32_bf16 v113, v13, v13
    v_dot2c_f32_bf16 v109, v14, v108
    v_dot2c_f32_bf16 v112, v14, v14
    v_dot2c_f32_bf16 v110, v15, v108
    v_dot2c_f32_bf16 v113, v15, v15
    s_waitcnt vmcnt(6)
    v_dot2c_f32_bf16 v109, v16, v108
    v_dot2c_f32_bf16 v112, v16, v16
    v_dot2c_f32_bf16 v110, v17, v108
    v_dot2c_f32_bf16 v113, v17, v17
    v_dot2c_f32_bf16 v109, v18, v108
    v_dot2c_f32_bf16 v112, v18, v18
    v_dot2c_f32_bf16 v110, v19, v108
    v_dot2c_f32_bf16 v113, v19, v19
    s_waitcnt vmcnt(5)
    v_dot2c_f32_bf16 v109, v20, v108
    v_dot2c_f32_bf16 v112, v20, v20
    v_dot2c_f32_bf16 v110, v21, v108
    v_dot2c_f32_bf16 v113, v21, v21
    v_dot2c_f32_bf16 v109, v22, v108
    v_dot2c_f32_bf16 v112, v22, v22
    v_dot2c_f32_bf16 v110, v23, v108
    v_dot2c_f32_bf16 v113, v23, v23
    s_waitcnt vmcnt(4)
    v_dot2c_f32_bf16 v109, v24, v108
    v_dot2c_f32_bf16 v112, v24, v24
    v_dot2c_f32_bf16 v110, v25, v108
    v_dot2c_f32_bf16 v113, v25, v25
    v_dot2c_f32_bf16 v109, v26, v108
    v_dot2c_f32_bf16 v112, v26, v26
    v_dot2c_f32_bf16 v110, v27, v108
    v_dot2c_f32_bf16 v113, v27, v27
    s_waitcnt vmcnt(3)
    v_dot2c_f32_bf16 v109, v28, v108
    v_dot2c_f32_bf16 v112, v28, v28
    v_dot2c_f32_bf16 v110, v29, v108
    v_dot2c_f32_bf16 v113, v29, v29
    v_dot2c_f32_bf16 v109, v30, v108
    v_dot2c_f32_bf16 v112, v30, v30
    v_dot2c_f32_bf16 v110, v31, v108
    v_dot2c_f32_bf16 v113, v31, v31
    s_waitcnt vmcnt(2)
    v_dot2c_f32_bf16 v109, v32, v108
    v_dot2c_f32_bf16 v112, v32, v32
    v_dot2c_f32_bf16 v110, v33, v108
    v_dot2c_f32_bf16 v113, v33, v33
    v_dot2c_f32_bf16 v109, v34, v108
    v_dot2c_f32_bf16 v112, v34, v34
    v_dot2c_f32_bf16 v110, v35, v108
    v_dot2c_f32_bf16 v113, v35, v35
    s_waitcnt vmcnt(1)
    v_dot2c_f32_bf16 v109, v36, v108
    v_dot2c_f32_bf16 v112, v36, v36
    v_dot2c_f32_bf16 v110, v37, v108
    v_dot2c_f32_bf16 v113, v37, v37
    v_dot2c_f32_bf16 v109, v38, v108
    v_dot2c_f32_bf16 v112, v38, v38
    v_dot2c_f32_bf16 v110, v39, v108
    v_dot2c_f32_bf16 v113, v39, v39
    s_waitcnt vmcnt(0)
    v_dot2c_f32_bf16 v109, v40, v108
    v_dot2c_f32_bf16 v112, v40, v40
    v_dot2c_f32_bf16 v110, v41, v108
    v_dot2c_f32_bf16 v113, v41, v41
    v_dot2c_f32_bf16 v109, v42, v108
    v_dot2c_f32_bf16 v112, v42, v42
    v_dot2c_f32_bf16 v110, v43, v108
    v_dot2c_f32_bf16 v113, v43, v43
    s_nop 1
    v_add_f32 v109, v109, v110
    v_add_f32 v112, v112, v113
    s_nop 0
    v_add_f32_dpp v109, v109, v109 quad_perm:[1,0,3,2] row_mask:0xf bank_mask:0xf
    v_add_f32_dpp v112, v112, v112 quad_perm:[1,0,3,2] row_mask:0xf bank_mask:0xf
    s_nop 0
    v_add_f32_dpp v109, v109, v109 quad_perm:[2,3,0,1] row_mask:0xf bank_mask:0xf
    v_add_f32_dpp v112, v112, v112 quad_perm:[2,3,0,1] row_mask:0xf bank_mask:0xf
    s_nop 0
    v_add_f32_dpp v109, v109, v109 row_half_mirror row_mask:0xf bank_mask:0xf
    v_add_f32_dpp v112, v112, v112 row_half_mirror row_mask:0xf bank_mask:0xf
    v_mul_f32 v109, 0xbb000000, v109
    v_mul_f32 v2, v109, v109
    v_mov_b32 v3, 0x3b000000
    v_fma_f32 v2, v112, v3, -v2
    v_max_f32 v2, 0, v2
    v_add_f32 v2, 0x3727c5ac, v2
    v_rsq_f32 v112, v2
    s_nop 0
    v_mul_f32 v114, v109, v112
    v_mov_b32 v113, v112
    v_mov_b32 v115, v114
    s_mov_b32 s38, 0xffff0000
    v_lshlrev_b32 v116, 16, v12
    v_and_b32 v117, s38, v12
    v_lshlrev_b32 v118, 16, v13
    v_and_b32 v119, s38, v13
    v_lshlrev_b32 v120, 16, v14
    v_and_b32 v121, s38, v14
    v_lshlrev_b32 v122, 16, v15
    v_and_b32 v123, s38, v15
    v_pk_fma_f32 v[116:117], v[116:117], v[112:113], v[114:115]
    v_pk_fma_f32 v[118:119], v[118:119], v[112:113], v[114:115]
    v_pk_fma_f32 v[120:121], v[120:121], v[112:113], v[114:115]
    v_pk_fma_f32 v[122:123], v[122:123], v[112:113], v[114:115]
    v_cvt_pk_bf16_f32 v12, v116, v117
    v_cvt_pk_bf16_f32 v13, v118, v119
    v_cvt_pk_bf16_f32 v14, v120, v121
    v_cvt_pk_bf16_f32 v15, v122, v123
    ds_write_b128 v11, v[12:15] offset:0
    v_lshlrev_b32 v116, 16, v16
    v_and_b32 v117, s38, v16
    v_lshlrev_b32 v118, 16, v17
    v_and_b32 v119, s38, v17
    v_lshlrev_b32 v120, 16, v18
    v_and_b32 v121, s38, v18
    v_lshlrev_b32 v122, 16, v19
    v_and_b32 v123, s38, v19
    v_pk_fma_f32 v[116:117], v[116:117], v[112:113], v[114:115]
    v_pk_fma_f32 v[118:119], v[118:119], v[112:113], v[114:115]
    v_pk_fma_f32 v[120:121], v[120:121], v[112:113], v[114:115]
    v_pk_fma_f32 v[122:123], v[122:123], v[112:113], v[114:115]
    v_cvt_pk_bf16_f32 v16, v116, v117
    v_cvt_pk_bf16_f32 v17, v118, v119
    v_cvt_pk_bf16_f32 v18, v120, v121
    v_cvt_pk_bf16_f32 v19, v122, v123
    ds_write_b128 v11, v[16:19] offset:4096
    v_lshlrev_b32 v116, 16, v20
    v_and_b32 v117, s38, v20
    v_lshlrev_b32 v118, 16, v21
    v_and_b32 v119, s38, v21
    v_lshlrev_b32 v120, 16, v22
    v_and_b32 v121, s38, v22
    v_lshlrev_b32 v122, 16, v23
    v_and_b32 v123, s38, v23
    v_pk_fma_f32 v[116:117], v[116:117], v[112:113], v[114:115]
    v_pk_fma_f32 v[118:119], v[118:119], v[112:113], v[114:115]
    v_pk_fma_f32 v[120:121], v[120:121], v[112:113], v[114:115]
    v_pk_fma_f32 v[122:123], v[122:123], v[112:113], v[114:115]
    v_cvt_pk_bf16_f32 v20, v116, v117
    v_cvt_pk_bf16_f32 v21, v118, v119
    v_cvt_pk_bf16_f32 v22, v120, v121
    v_cvt_pk_bf16_f32 v23, v122, v123
    ds_write_b128 v11, v[20:23] offset:8192
    v_lshlrev_b32 v116, 16, v24
    v_and_b32 v117, s38, v24
    v_lshlrev_b32 v118, 16, v25
    v_and_b32 v119, s38, v25
    v_lshlrev_b32 v120, 16, v26
    v_and_b32 v121, s38, v26
    v_lshlrev_b32 v122, 16, v27
    v_and_b32 v123, s38, v27
    v_pk_fma_f32 v[116:117], v[116:117], v[112:113], v[114:115]
    v_pk_fma_f32 v[118:119], v[118:119], v[112:113], v[114:115]
    v_pk_fma_f32 v[120:121], v[120:121], v[112:113], v[114:115]
    v_pk_fma_f32 v[122:123], v[122:123], v[112:113], v[114:115]
    v_cvt_pk_bf16_f32 v24, v116, v117
    v_cvt_pk_bf16_f32 v25, v118, v119
    v_cvt_pk_bf16_f32 v26, v120, v121
    v_cvt_pk_bf16_f32 v27, v122, v123
    ds_write_b128 v11, v[24:27] offset:12288
    v_lshlrev_b32 v116, 16, v28
    v_and_b32 v117, s38, v28
    v_lshlrev_b32 v118, 16, v29
    v_and_b32 v119, s38, v29
    v_lshlrev_b32 v120, 16, v30
    v_and_b32 v121, s38, v30
    v_lshlrev_b32 v122, 16, v31
    v_and_b32 v123, s38, v31
    v_pk_fma_f32 v[116:117], v[116:117], v[112:113], v[114:115]
    v_pk_fma_f32 v[118:119], v[118:119], v[112:113], v[114:115]
    v_pk_fma_f32 v[120:121], v[120:121], v[112:113], v[114:115]
    v_pk_fma_f32 v[122:123], v[122:123], v[112:113], v[114:115]
    v_cvt_pk_bf16_f32 v28, v116, v117
    v_cvt_pk_bf16_f32 v29, v118, v119
    v_cvt_pk_bf16_f32 v30, v120, v121
    v_cvt_pk_bf16_f32 v31, v122, v123
    ds_write_b128 v11, v[28:31] offset:16384
    v_lshlrev_b32 v116, 16, v32
    v_and_b32 v117, s38, v32
    v_lshlrev_b32 v118, 16, v33
    v_and_b32 v119, s38, v33
    v_lshlrev_b32 v120, 16, v34
    v_and_b32 v121, s38, v34
    v_lshlrev_b32 v122, 16, v35
    v_and_b32 v123, s38, v35
    v_pk_fma_f32 v[116:117], v[116:117], v[112:113], v[114:115]
    v_pk_fma_f32 v[118:119], v[118:119], v[112:113], v[114:115]
    v_pk_fma_f32 v[120:121], v[120:121], v[112:113], v[114:115]
    v_pk_fma_f32 v[122:123], v[122:123], v[112:113], v[114:115]
    v_cvt_pk_bf16_f32 v32, v116, v117
    v_cvt_pk_bf16_f32 v33, v118, v119
    v_cvt_pk_bf16_f32 v34, v120, v121
    v_cvt_pk_bf16_f32 v35, v122, v123
    ds_write_b128 v11, v[32:35] offset:20480
    v_lshlrev_b32 v116, 16, v36
    v_and_b32 v117, s38, v36
    v_lshlrev_b32 v118, 16, v37
    v_and_b32 v119, s38, v37
    v_lshlrev_b32 v120, 16, v38
    v_and_b32 v121, s38, v38
    v_lshlrev_b32 v122, 16, v39
    v_and_b32 v123, s38, v39
    v_pk_fma_f32 v[116:117], v[116:117], v[112:113], v[114:115]
    v_pk_fma_f32 v[118:119], v[118:119], v[112:113], v[114:115]
    v_pk_fma_f32 v[120:121], v[120:121], v[112:113], v[114:115]
    v_pk_fma_f32 v[122:123], v[122:123], v[112:113], v[114:115]
    v_cvt_pk_bf16_f32 v36, v116, v117
    v_cvt_pk_bf16_f32 v37, v118, v119
    v_cvt_pk_bf16_f32 v38, v120, v121
    v_cvt_pk_bf16_f32 v39, v122, v123
    ds_write_b128 v11, v[36:39] offset:24576
    v_lshlrev_b32 v116, 16, v40
    v_and_b32 v117, s38, v40
    v_lshlrev_b32 v118, 16, v41
    v_and_b32 v119, s38, v41
    v_lshlrev_b32 v120, 16, v42
    v_and_b32 v121, s38, v42
    v_lshlrev_b32 v122, 16, v43
    v_and_b32 v123, s38, v43
    v_pk_fma_f32 v[116:117], v[116:117], v[112:113], v[114:115]
    v_pk_fma_f32 v[118:119], v[118:119], v[112:113], v[114:115]
    v_pk_fma_f32 v[120:121], v[120:121], v[112:113], v[114:115]
    v_pk_fma_f32 v[122:123], v[122:123], v[112:113], v[114:115]
    v_cvt_pk_bf16_f32 v40, v116, v117
    v_cvt_pk_bf16_f32 v41, v118, v119
    v_cvt_pk_bf16_f32 v42, v120, v121
    v_cvt_pk_bf16_f32 v43, v122, v123
    ds_write_b128 v11, v[40:43] offset:28672
    s_mov_b32 s40, 0
    s_lshl_b32 s36, s31, 12
    v_add_u32 v44, s36, v6
    v_add_u32 v45, s36, v7
    v_add_u32 v46, s36, v8
    v_add_u32 v47, s36, v9
    s_and_b32 s36, s40, 3
    s_mul_i32 s36, s36, 24576
    v_add_u32 v49, s36, v48
    s_add_u32 s31, s31, 1
    s_and_b32 s31, s31, 7
    s_lshl_b32 s35, s27, 2
    s_lshl_b32 s36, s30, 1
    s_add_u32 s35, s35, s36
    s_lshl_b32 s36, s28, 1
    s_add_u32 s36, s36, s29
    s_lshl_b32 s37, s35, 6
    s_add_u32 s37, s37, s36
    s_lshl_b32 s42, s37, 10
    s_lshl_b32 s39, s37, 2
    s_add_u32 s39, s39, 17825792
    s_waitcnt lgkmcnt(0)
    s_cmp_ge_u32 s24, 4
    s_cbranch_scc1 qkv_v
qkv_loop_qk:
    s_barrier
    v_mfma_f32_32x32x16_bf16 v[76:91], v[68:71], v[56:59], v[76:91]
    ds_read_b128 v[52:55], v44
    ds_read_b64_tr_b16 v[60:61], v49 offset:0
    ds_read_b64_tr_b16 v[62:63], v49 offset:1536
    v_mfma_f32_32x32x16_bf16 v[92:107], v[72:75], v[56:59], v[92:107]
    ds_read_b64_tr_b16 v[64:65], v49 offset:128
    ds_read_b64_tr_b16 v[66:67], v49 offset:1664
    s_waitcnt lgkmcnt(2)
    v_mfma_f32_32x32x16_bf16 v[76:91], v[60:63], v[52:55], v[76:91]
    ds_read_b128 v[56:59], v45
    ds_read_b64_tr_b16 v[68:69], v49 offset:6144
    ds_read_b64_tr_b16 v[70:71], v49 offset:7680
    s_waitcnt lgkmcnt(3)
    v_mfma_f32_32x32x16_bf16 v[92:107], v[64:67], v[52:55], v[92:107]
    ds_read_b64_tr_b16 v[72:73], v49 offset:6272
    ds_read_b64_tr_b16 v[74:75], v49 offset:7808
    s_waitcnt lgkmcnt(2)
    v_mfma_f32_32x32x16_bf16 v[76:91], v[68:71], v[56:59], v[76:91]
    ds_read_b128 v[52:55], v46
    ds_read_b64_tr_b16 v[60:61], v49 offset:12288
    ds_read_b64_tr_b16 v[62:63], v49 offset:13824
    s_waitcnt lgkmcnt(3)
    v_mfma_f32_32x32x16_bf16 v[92:107], v[72:75], v[56:59], v[92:107]
    ds_read_b64_tr_b16 v[64:65], v49 offset:12416
    ds_read_b64_tr_b16 v[66:67], v49 offset:13952
    s_waitcnt lgkmcnt(2)
    v_mfma_f32_32x32x16_bf16 v[76:91], v[60:63], v[52:55], v[76:91]
    ds_read_b128 v[56:59], v47
    ds_read_b64_tr_b16 v[68:69], v49 offset:18432
    ds_read_b64_tr_b16 v[70:71], v49 offset:19968
    s_waitcnt lgkmcnt(3)
    v_mfma_f32_32x32x16_bf16 v[92:107], v[64:67], v[52:55], v[92:107]
    ds_read_b64_tr_b16 v[72:73], v49 offset:18560
    ds_read_b64_tr_b16 v[74:75], v49 offset:20096
    s_add_u32 s40, s40, 1
    s_lshl_b32 s36, s31, 12
    v_add_u32 v44, s36, v6
    v_add_u32 v45, s36, v7
    v_add_u32 v46, s36, v8
    v_add_u32 v47, s36, v9
    s_and_b32 s36, s40, 3
    s_mul_i32 s36, s36, 24576
    v_add_u32 v49, s36, v48
    s_add_u32 s31, s31, 1
    s_and_b32 s31, s31, 7
    s_cmp_lt_u32 s40, 8
    s_waitcnt lgkmcnt(0)
    s_cbranch_scc1 qkv_loop_qk
    v_mfma_f32_32x32x16_bf16 v[76:91], v[68:71], v[56:59], v[76:91]
    v_mfma_f32_32x32x16_bf16 v[92:107], v[72:75], v[56:59], v[92:107]
    v_lshlrev_b32 v5, 4, v1
    s_mov_b32 s41, 0x3eb8aa3b
    s_add_u32 s43, s42, 2097152
    s_add_u32 s44, s42, 2162688
    s_add_u32 s45, s42, 65536
    s_nop 6
    v_cvt_pk_bf16_f32 v20, v92, v93
    v_cvt_pk_bf16_f32 v21, v94, v95
    v_cvt_pk_bf16_f32 v22, v96, v97
    v_cvt_pk_bf16_f32 v23, v98, v99
    buffer_store_dwordx4 v[20:23], v5, s[20:23], s43 offen
    v_cvt_pk_bf16_f32 v24, v100, v101
    v_cvt_pk_bf16_f32 v25, v102, v103
    v_cvt_pk_bf16_f32 v26, v104, v105
    v_cvt_pk_bf16_f32 v27, v106, v107
    buffer_store_dwordx4 v[24:27], v5, s[20:23], s44 offen
    v_mul_f32 v76, s41, v76
    v_mul_f32 v77, s41, v77
    v_mul_f32 v78, s41, v78
    v_mul_f32 v79, s41, v79
    v_mul_f32 v80, s41, v80
    v_mul_f32 v81, s41, v81
    v_mul_f32 v82, s41, v82
    v_mul_f32 v83, s41, v83
    v_mul_f32 v84, s41, v84
    v_mul_f32 v85, s41, v85
    v_mul_f32 v86, s41, v86
    v_mul_f32 v87, s41, v87
    v_mul_f32 v88, s41, v88
    v_mul_f32 v89, s41, v89
    v_mul_f32 v90, s41, v90
    v_mul_f32 v91, s41, v91
    v_cvt_pk_bf16_f32 v12, v76, v77
    v_cvt_pk_bf16_f32 v13, v78, v79
    v_cvt_pk_bf16_f32 v14, v80, v81
    v_cvt_pk_bf16_f32 v15, v82, v83
    buffer_store_dwordx4 v[12:15], v5, s[20:23], s42 offen
    v_cvt_pk_bf16_f32 v16, v84, v85
    v_cvt_pk_bf16_f32 v17, v86, v87
    v_cvt_pk_bf16_f32 v18, v88, v89
    v_cvt_pk_bf16_f32 v19, v90, v91
    buffer_store_dwordx4 v[16:19], v5, s[20:23], s45 offen
    v_mov_b32 v109, 0
    v_mov_b32 v110, 0
    v_dot2c_f32_bf16 v109, v20, v20
    v_dot2c_f32_bf16 v110, v24, v24
    v_dot2c_f32_bf16 v109, v21, v21
    v_dot2c_f32_bf16 v110, v25, v25
    v_dot2c_f32_bf16 v109, v22, v22
    v_dot2c_f32_bf16 v110, v26, v26
    v_dot2c_f32_bf16 v109, v23, v23
    v_dot2c_f32_bf16 v110, v27, v27
    s_nop 1
    v_mov_b32 v2, v109
    s_nop 1
    v_permlane32_swap_b32 v109, v2
    v_add_f32 v109, v109, v2
    v_mov_b32 v3, v110
    s_nop 1
    v_permlane32_swap_b32 v110, v3
    v_add_f32 v110, v110, v3
    v_max_f32_dpp v109, v109, v109 row_shr:1 row_mask:0xf bank_mask:0xf bound_ctrl:0
    s_nop 0
    v_max_f32_dpp v110, v110, v110 row_shr:1 row_mask:0xf bank_mask:0xf bound_ctrl:0
    v_max_f32_dpp v109, v109, v109 row_shr:2 row_mask:0xf bank_mask:0xf bound_ctrl:0
    s_nop 0
    v_max_f32_dpp v110, v110, v110 row_shr:2 row_mask:0xf bank_mask:0xf bound_ctrl:0
    v_max_f32_dpp v109, v109, v109 row_shr:4 row_mask:0xf bank_mask:0xf bound_ctrl:0
    s_nop 0
    v_max_f32_dpp v110, v110, v110 row_shr:4 row_mask:0xf bank_mask:0xf bound_ctrl:0
    v_max_f32_dpp v109, v109, v109 row_shr:8 row_mask:0xf bank_mask:0xf bound_ctrl:0
    s_nop 0
    v_max_f32_dpp v110, v110, v110 row_shr:8 row_mask:0xf bank_mask:0xf bound_ctrl:0
    v_max_f32_dpp v109, v109, v109 row_bcast:15 row_mask:0xa bank_mask:0xf
    s_nop 0
    v_max_f32_dpp v110, v110, v110 row_bcast:15 row_mask:0xa bank_mask:0xf
    v_mov_b32 v2, 0
    s_mov_b32 exec_lo, 0x80000000
    s_mov_b32 exec_hi, 0
    buffer_store_dword v109, v2, s[20:23], s39 offen
    buffer_store_dword v110, v2, s[20:23], s39 offen offset:256
    s_branch qkv_done
qkv_v:
qkv_loop_v:
    s_barrier
    v_mfma_f32_32x32x16_bf16 v[76:91], v[56:59], v[68:71], v[76:91]
    ds_read_b128 v[52:55], v44
    ds_read_b64_tr_b16 v[60:61], v49 offset:256
    ds_read_b64_tr_b16 v[62:63], v49 offset:1792
    s_waitcnt lgkmcnt(0)
    v_mfma_f32_32x32x16_bf16 v[76:91], v[52:55], v[60:63], v[76:91]
    ds_read_b128 v[56:59], v45
    ds_read_b64_tr_b16 v[68:69], v49 offset:6400
    ds_read_b64_tr_b16 v[70:71], v49 offset:7936
    s_waitcnt lgkmcnt(0)
    v_mfma_f32_32x32x16_bf16 v[76:91], v[56:59], v[68:71], v[76:91]
    ds_read_b128 v[52:55], v46
    ds_read_b64_tr_b16 v[60:61], v49 offset:12544
    ds_read_b64_tr_b16 v[62:63], v49 offset:14080
    s_waitcnt lgkmcnt(0)
    v_mfma_f32_32x32x16_bf16 v[76:91], v[52:55], v[60:63], v[76:91]
    ds_read_b128 v[56:59], v47
    ds_read_b64_tr_b16 v[68:69], v49 offset:18688
    ds_read_b64_tr_b16 v[70:71], v49 offset:20224
    s_add_u32 s40, s40, 1
    s_lshl_b32 s36, s31, 12
    v_add_u32 v44, s36, v6
    v_add_u32 v45, s36, v7
    v_add_u32 v46, s36, v8
    v_add_u32 v47, s36, v9
    s_and_b32 s36, s40, 3
    s_mul_i32 s36, s36, 24576
    v_add_u32 v49, s36, v48
    s_add_u32 s31, s31, 1
    s_and_b32 s31, s31, 7
    s_cmp_lt_u32 s40, 8
    s_waitcnt lgkmcnt(0)
    s_cbranch_scc1 qkv_loop_v
    v_mfma_f32_32x32x16_bf16 v[76:91], v[56:59], v[68:71], v[76:91]
    v_bfe_u32 v2, v1, 4, 1
    v_lshlrev_b32 v2, 16, v2
    v_lshrrev_b32 v3, 5, v1
    v_lshl_add_u32 v2, v3, 8, v2
    v_and_b32 v3, 15, v1
    v_lshl_add_u32 v5, v3, 4, v2
    s_add_u32 s43, s42, 4194304
    s_nop 4
    v_cvt_pk_bf16_f32 v12, v76, v77
    v_cvt_pk_bf16_f32 v13, v78, v79
    v_cvt_pk_bf16_f32 v14, v80, v81
    v_cvt_pk_bf16_f32 v15, v82, v83
    buffer_store_dwordx4 v[12:15], v5, s[20:23], s43 offen offset:0
    v_cvt_pk_bf16_f32 v16, v84, v85
    v_cvt_pk_bf16_f32 v17, v86, v87
    v_cvt_pk_bf16_f32 v18, v88, v89
    v_cvt_pk_bf16_f32 v19, v90, v91
    buffer_store_dwordx4 v[16:19], v5, s[20:23], s43 offen offset:512
    s_branch qkv_done
qkv_ld:
    v_add_u32 v2, 0, v1
    v_mul_u32_u24 v3, 171, v2
    v_lshrrev_b32 v3, 12, v3
    v_mul_u32_u24 v4, 24, v3
    v_sub_u32 v2, v2, v4
    v_bfe_u32 v4, v3, 1, 1
    v_lshlrev_b32 v4, 2, v4
    v_xor_b32 v2, v2, v4
    v_lshrrev_b32 v4, 3, v2
    v_and_b32 v2, 7, v2
    v_mul_u32_u24 v3, 3072, v3
    v_lshl_add_u32 v3, v4, 10, v3
    v_lshl_add_u32 v6, v2, 4, v3
    v_add_u32 v2, 64, v1
    v_mul_u32_u24 v3, 171, v2
    v_lshrrev_b32 v3, 12, v3
    v_mul_u32_u24 v4, 24, v3
    v_sub_u32 v2, v2, v4
    v_bfe_u32 v4, v3, 1, 1
    v_lshlrev_b32 v4, 2, v4
    v_xor_b32 v2, v2, v4
    v_lshrrev_b32 v4, 3, v2
    v_and_b32 v2, 7, v2
    v_mul_u32_u24 v3, 3072, v3
    v_lshl_add_u32 v3, v4, 10, v3
    v_lshl_add_u32 v7, v2, 4, v3
    v_add_u32 v2, 128, v1
    v_mul_u32_u24 v3, 171, v2
    v_lshrrev_b32 v3, 12, v3
    v_mul_u32_u24 v4, 24, v3
    v_sub_u32 v2, v2, v4
    v_bfe_u32 v4, v3, 1, 1
    v_lshlrev_b32 v4, 2, v4
    v_xor_b32 v2, v2, v4
    v_lshrrev_b32 v4, 3, v2
    v_and_b32 v2, 7, v2
    v_mul_u32_u24 v3, 3072, v3
    v_lshl_add_u32 v3, v4, 10, v3
    v_lshl_add_u32 v8, v2, 4, v3
    s_and_b32 s33, s24, 3
    s_mul_i32 s34, s33, 49152
    s_lshl_b32 s35, s27, 7
    s_add_u32 s34, s34, s35
    s_mul_i32 s35, s33, 6144
    s_add_u32 s35, s35, 65536
    s_add_u32 s38, s35, 98304
    s_waitcnt lgkmcnt(0)
    s_mov_b32 s16, s6
    s_and_b32 s17, s7, 0xffff
    s_mov_b32 s18, 1572864
    s_mov_b32 s19, 0x20000
    s_mov_b32 s20, s8
    s_and_b32 s21, s9, 0xffff
    s_mov_b32 s22, 24379392
    s_mov_b32 s23, 0x20000
    s_mov_b32 s40, 0
qkv_lloop:
    s_mul_i32 s36, s31, 196608
    s_add_u32 s36, s36, s34
    s_add_u32 s37, s36, 24576
    s_add_u32 m0, s35, 0
    s_add_u32 s31, s31, 1
    buffer_load_dwordx4 v6, s[16:19], s36 offen lds
    s_add_u32 m0, s35, 1024
    s_and_b32 s31, s31, 7
    buffer_load_dwordx4 v7, s[16:19], s36 offen lds
    s_add_u32 m0, s35, 2048
    s_nop 0
    buffer_load_dwordx4 v8, s[16:19], s36 offen lds
    s_add_u32 m0, s35, 3072
    s_nop 0
    buffer_load_dwordx4 v6, s[16:19], s37 offen lds
    s_add_u32 m0, s35, 4096
    s_nop 0
    buffer_load_dwordx4 v7, s[16:19], s37 offen lds
    s_add_u32 m0, s35, 5120
    s_nop 0
    buffer_load_dwordx4 v8, s[16:19], s37 offen lds
    s_add_u32 s35, s35, 24576
    s_cmp_eq_u32 s35, s38
    s_cselect_b32 s36, 98304, 0
    s_sub_u32 s35, s35, s36
    s_add_u32 s40, s40, 1
    s_cmp_gt_u32 s40, 3
    s_cbranch_scc1 qkv_lsteady
    s_branch qkv_lloop
qkv_lsteady:
    s_cmp_lg_u32 s40, 4
    s_cbranch_scc1 qkv_lst2
    s_waitcnt vmcnt(18)
    s_barrier
qkv_lst2:
    s_waitcnt vmcnt(12)
    s_barrier
    s_cmp_lt_u32 s40, 8
    s_cbranch_scc1 qkv_lloop
    s_lshl_b32 s36, s26, 2
    s_add_u32 s36, s36, s33
    v_lshlrev_b32 v2, 4, v1
    s_waitcnt vmcnt(6)
    s_lshl_b32 s36, s2, 2
    s_add_u32 s36, s36, s33
    s_cmp_ge_u32 s36, 8
    s_cbranch_scc1 qkv_nozero
    v_mov_b32 v16, 0
    v_mov_b32 v17, 0
    v_mov_b32 v18, 0
    v_mov_b32 v19, 0
    s_lshl_b32 s36, s36, 10
    s_add_u32 s36, s36, 18219008
    buffer_store_dwordx4 v[16:19], v2, s[20:23], s36 offen
qkv_nozero:
    v_mov_b32 v20, -1
    v_mov_b32 v21, -1
    v_mov_b32 v22, -1
    v_mov_b32 v23, -1
    s_lshl_b32 s36, s2, 2
    s_add_u32 s36, s36, s33
    s_lshl_b32 s36, s36, 11
    s_add_u32 s36, s36, 6291456
    buffer_store_dwordx4 v[20:23], v2, s[20:23], s36 offen
    buffer_store_dwordx4 v[20:23], v2, s[20:23], s36 offen offset:1024
    s_lshl_b32 s36, s2, 2
    s_add_u32 s36, s36, s33
    s_cmp_ge_u32 s36, 512
    s_cbranch_scc1 qkv_notag
    s_lshr_b32 s37, s36, 3
    s_lshl_b32 s37, s37, 15
    s_and_b32 s36, s36, 7
    s_lshl_b32 s36, s36, 10
    s_add_u32 s36, s36, s37
    s_add_u32 s36, s36, 8388608
    buffer_store_dwordx4 v[20:23], v2, s[20:23], s36 offen
qkv_notag:
    s_waitcnt vmcnt(10)
    s_barrier
    s_waitcnt vmcnt(0)
    s_barrier
    s_branch qkv_done
qkv_done:
qkv_end:
    s_endpgm
.globl fused_kernel
.p2align 8
.type fused_kernel,@function
fused_kernel:
    s_cmp_ge_u32 s2, 256
    s_cbranch_scc1 f_end
    s_load_dwordx2 s[8:9], s[0:1], 72
    s_load_dwordx4 s[4:7], s[0:1], 32
    s_load_dwordx4 s[28:31], s[0:1], 48
    s_load_dwordx2 s[32:33], s[0:1], 0
    s_load_dwordx2 s[34:35], s[0:1], 16
    v_and_b32 v1, 63, v0
    v_lshrrev_b32 v2, 6, v0
    v_lshlrev_b32 v4, 4, v1
    v_readfirstlane_b32 s24, v2
    s_and_b32 s25, s2, 7
    s_lshr_b32 s26, s2, 3
    s_and_b32 s27, s26, 7
    s_lshl_b32 s27, s27, 3
    s_add_u32 s27, s27, s24
    s_lshl_b32 s43, s25, 2
    s_lshr_b32 s38, s26, 3
    s_add_u32 s43, s43, s38
    s_lshl_b32 s38, s43, 16
    s_lshl_b32 s39, s24, 10
    s_add_u32 s40, s38, s39
    s_add_u32 s40, s40, 2097152
    s_lshl_b32 s41, s27, 10
    s_add_u32 s41, s41, s38
    s_lshl_b32 s42, s43, 8
    s_add_u32 s42, s42, 17825792
    v_lshlrev_b32 v2, 2, v1
    s_waitcnt lgkmcnt(0)
    s_mov_b32 s20, s8
    s_and_b32 s21, s9, 0xffff
    s_mov_b32 s22, 24379392
    s_mov_b32 s23, 0x20000
    buffer_load_dwordx4 v[12:15], v4, s[20:23], s41 offen
    buffer_load_dword v10, v2, s[20:23], s42 offen
    s_add_u32 m0, s39, 0
    s_add_u32 s41, s40, 0
    buffer_load_dwordx4 v4, s[20:23], s41 offen lds
    s_add_u32 m0, s39, 65536
    s_add_u32 s41, s40, 2097152
    buffer_load_dwordx4 v4, s[20:23], s41 offen lds
    v_mov_b32 v5, v4
    v_lshrrev_b32 v2, 5, v1
    v_lshlrev_b32 v2, 8, v2
    v_and_b32 v3, 15, v1
    v_lshl_add_u32 v2, v3, 4, v2
    v_add_u32 v6, 65536, v2
    v_mov_b32 v40, 0x3f803f80
    v_mov_b32 v41, 0x3f803f80
    v_mov_b32 v42, 0x3f803f80
    v_mov_b32 v43, 0x3f803f80
    s_mov_b32 s36, 0xffff
    s_mov_b32 s37, 0xffff
    v_and_b32 v2, 27, v1
    v_cmp_eq_u32 vcc, 16, v2
    s_nop 1
    v_cndmask_b32 v3, 0, v40, vcc
    v_mov_b32 v24, v3
    v_mov_b32 v25, v3
    v_mov_b32 v26, v3
    v_mov_b32 v27, v3
    v_mov_b32 v28, v3
    v_mov_b32 v29, v3
    v_mov_b32 v30, v3
    v_mov_b32 v31, v3
    v_mov_b32 v32, v3
    v_mov_b32 v33, v3
    v_mov_b32 v34, v3
    v_mov_b32 v35, v3
    v_mov_b32 v36, v3
    v_mov_b32 v37, v3
    v_mov_b32 v38, v3
    v_mov_b32 v39, v3
    v_mov_b32 v76, 0
    v_mov_b32 v77, 0
    v_mov_b32 v78, 0
    v_mov_b32 v79, 0
    v_mov_b32 v80, 0
    v_mov_b32 v81, 0
    v_mov_b32 v82, 0
    v_mov_b32 v83, 0
    v_mov_b32 v84, 0
    v_mov_b32 v85, 0
    v_mov_b32 v86, 0
    v_mov_b32 v87, 0
    v_mov_b32 v88, 0
    v_mov_b32 v89, 0
    v_mov_b32 v90, 0
    v_mov_b32 v91, 0
    v_mov_b32 v108, 0
    v_mov_b32 v109, 0
    v_mov_b32 v110, 0
    v_mov_b32 v111, 0
    v_mov_b32 v112, 0
    v_mov_b32 v113, 0
    v_mov_b32 v114, 0
    v_mov_b32 v115, 0
    v_mov_b32 v116, 0
    v_mov_b32 v117, 0
    v_mov_b32 v118, 0
    v_mov_b32 v119, 0
    v_mov_b32 v120, 0
    v_mov_b32 v121, 0
    v_mov_b32 v122, 0
    v_mov_b32 v123, 0
    v_mov_b32 v68, 0
    v_mov_b32 v69, 0
    v_mov_b32 v70, 0
    v_mov_b32 v71, 0
    s_waitcnt vmcnt(2)
    v_max_f32_dpp v10, v10, v10 row_shr:1 row_mask:0xf bank_mask:0xf bound_ctrl:0
    s_nop 1
    v_max_f32_dpp v10, v10, v10 row_shr:2 row_mask:0xf bank_mask:0xf bound_ctrl:0
    s_nop 1
    v_max_f32_dpp v10, v10, v10 row_shr:4 row_mask:0xf bank_mask:0xf bound_ctrl:0
    s_nop 1
    v_max_f32_dpp v10, v10, v10 row_shr:8 row_mask:0xf bank_mask:0xf bound_ctrl:0
    s_nop 1
    v_max_f32_dpp v10, v10, v10 row_bcast:15 row_mask:0xa bank_mask:0xf
    s_nop 1
    v_max_f32_dpp v10, v10, v10 row_bcast:31 row_mask:0xc bank_mask:0xf
    s_nop 0
    v_readlane_b32 s41, v10, 63
    v_mov_b32 v2, 0
    v_dot2c_f32_bf16 v2, v12, v12
    v_dot2c_f32_bf16 v2, v13, v13
    v_dot2c_f32_bf16 v2, v14, v14
    v_dot2c_f32_bf16 v2, v15, v15
    s_nop 2
    v_mov_b32 v3, v2
    s_nop 1
    v_permlane32_swap_b32 v2, v3
    v_add_f32 v2, v2, v3
    v_mul_f32 v2, s41, v2
    v_sqrt_f32 v2, v2
    v_mov_b32 v3, 0x3f820000
    v_fma_f32 v2, v2, v3, 0.5
    v_mov_b32 v3, 0x42700000
    v_cmp_nle_f32 vcc, v2, v3
    v_sub_f32 v2, 0x42200000, v2
    v_mov_b32 v92, v2
    v_mov_b32 v93, v2
    v_mov_b32 v94, v2
    v_mov_b32 v95, v2
    v_mov_b32 v96, v2
    v_mov_b32 v97, v2
    v_mov_b32 v98, v2
    v_mov_b32 v99, v2
    v_mov_b32 v100, v2
    v_mov_b32 v101, v2
    v_mov_b32 v102, v2
    v_mov_b32 v103, v2
    v_mov_b32 v104, v2
    v_mov_b32 v105, v2
    v_mov_b32 v106, v2
    v_mov_b32 v107, v2
    s_cbranch_vccnz f_slow
    s_waitcnt vmcnt(0)
    s_waitcnt lgkmcnt(0)
    s_barrier
    ds_read_b128 v[16:19], v5 offset:0
    ds_read_b128 v[20:23], v5 offset:1024
    s_mov_b64 exec, s[36:37]
    ds_read_b128 v[24:27], v6 offset:0
    ds_read_b128 v[28:31], v6 offset:512
    s_mov_b64 exec, -1
    s_waitcnt lgkmcnt(3)
    v_mfma_f32_32x32x16_bf16 v[44:59], v[16:19], v[12:15], v[92:107]
    s_add_u32 m0, s39, 8192
    s_add_u32 s41, s40, 8192
    buffer_load_dwordx4 v4, s[20:23], s41 offen lds
    s_add_u32 m0, s39, 73728
    s_add_u32 s41, s40, 2105344
    buffer_load_dwordx4 v4, s[20:23], s41 offen lds
    s_add_u32 m0, s39, 16384
    s_add_u32 s41, s40, 16384
    buffer_load_dwordx4 v4, s[20:23], s41 offen lds
    s_add_u32 m0, s39, 81920
    s_add_u32 s41, s40, 2113536
    buffer_load_dwordx4 v4, s[20:23], s41 offen lds
    s_mov_b32 s16, s30
    s_and_b32 s17, s31, 0xffff
    s_mov_b32 s18, 2097152
    s_mov_b32 s19, 0x20000
    s_mov_b32 s12, s32
    s_and_b32 s13, s33, 0xffff
    s_mov_b32 s14, 2097152
    s_mov_b32 s15, 0x20000
    s_mov_b32 s44, s34
    s_and_b32 s45, s35, 0xffff
    s_mov_b32 s46, 524288
    s_mov_b32 s47, 0x20000
    s_lshl_b32 s41, s2, 3
    s_add_u32 s41, s41, s24
    v_lshrrev_b32 v2, 3, v1
    v_and_b32 v3, 7, v1
    v_bfe_u32 v10, v1, 4, 1
    v_bfe_u32 v11, v1, 2, 2
    v_lshrrev_b32 v124, 5, v1
    v_lshl_add_u32 v11, v124, 2, v11
    v_lshlrev_b32 v124, 7, v11
    v_and_b32 v125, 3, v1
    v_lshl_add_u32 v124, v125, 3, v124
    s_lshl_b32 s31, s24, 12
    s_add_u32 s31, s31, 131072
    v_add_u32 v124, s31, v124
    s_cmp_ge_u32 s41, 896
    s_cbranch_scc1 f_rp_dn0
    s_mov_b32 s48, s4
    s_and_b32 s49, s5, 0xffff
    s_mov_b32 s50, 1835008
    s_mov_b32 s51, 0x20000
    s_mov_b32 s52, s6
    s_and_b32 s53, s7, 0xffff
    s_mov_b32 s54, 1835008
    s_mov_b32 s55, 0x20000
    s_mul_i32 s42, s41, 2341
    s_lshr_b32 s42, s42, 16
    s_mul_i32 s3, s42, 28
    s_sub_u32 s41, s41, s3
    s_mul_i32 s56, s42, 57344
    s_lshl_b32 s3, s41, 7
    s_add_u32 s56, s56, s3
    s_mov_b32 s57, s56
    s_add_u32 s58, s56, 28672
    s_mov_b32 s59, s58
    v_lshlrev_b32 v10, 1, v10
    v_xor_b32 v3, v3, v10
    v_lshlrev_b32 v3, 4, v3
    v_mul_u32_u24 v2, 3584, v2
    v_add_u32 v7, v2, v3
    v_xor_b32 v8, 64, v7
    v_bfe_u32 v2, v1, 3, 2
    v_lshl_add_u32 v124, v2, 5, v124
    v_bfe_u32 v2, v1, 4, 1
    v_lshl_add_u32 v124, v2, 10, v124
    v_xor_b32 v125, 32, v124
    v_xor_b32 v126, 64, v124
    v_xor_b32 v127, 96, v124
    s_lshl_b32 s60, s41, 17
    s_lshl_b32 s3, s42, 10
    s_add_u32 s60, s60, s3
    s_add_u32 s60, s60, 18874368
    s_add_u32 s61, s60, 32768
    s_add_u32 s62, s60, 65536
    s_add_u32 s63, s60, 98304
    s_branch f_rp_set0
f_rp_dn0:
    s_mov_b32 s48, s28
    s_and_b32 s49, s29, 0xffff
    s_mov_b32 s50, 1835008
    s_mov_b32 s51, 0x20000
    s_mov_b32 s52, s28
    s_and_b32 s53, s29, 0xffff
    s_mov_b32 s54, 1835008
    s_mov_b32 s55, 0x20000
    s_sub_u32 s41, s41, 896
    s_lshr_b32 s42, s41, 3
    s_and_b32 s41, s41, 7
    s_lshl_b32 s56, s42, 15
    s_lshl_b32 s3, s41, 7
    s_add_u32 s56, s56, s3
    s_add_u32 s57, s56, 16384
    s_add_u32 s58, s56, 8192
    s_add_u32 s59, s56, 24576
    v_lshlrev_b32 v10, 2, v10
    v_xor_b32 v3, v3, v10
    v_lshlrev_b32 v3, 4, v3
    v_lshl_add_u32 v7, v2, 10, v3
    v_mov_b32 v8, v7
    v_bfe_u32 v2, v1, 3, 1
    v_lshl_add_u32 v124, v2, 6, v124
    v_bfe_u32 v2, v1, 4, 1
    v_lshl_add_u32 v124, v2, 5, v124
    v_add_u32 v125, 1024, v124
    v_xor_b32 v126, 64, v124
    v_xor_b32 v127, 64, v125
    s_mul_i32 s60, s41, 229376
    s_lshl_b32 s3, s42, 11
    s_add_u32 s60, s60, s3
    s_add_u32 s60, s60, 22544384
    s_cmp_ge_u32 s42, 56
    s_cselect_b32 s60, 24379392, s60
    s_add_u32 s61, s60, 1024
    s_add_u32 s62, s60, 114688
    s_add_u32 s63, s60, 115712
f_rp_set0:
    s_and_b32 s28, s26, 15
    s_min_u32 s29, s24, 6
    s_mul_i32 s30, s28, 7
    s_add_u32 s30, s30, s29
    s_lshl_b32 s30, s30, 15
    s_add_u32 s30, s30, 18874368
    v_lshrrev_b32 v2, 3, v1
    v_bfe_u32 v3, v1, 2, 1
    v_bfe_u32 v9, v1, 4, 1
    v_xor_b32 v3, v3, v9
    v_lshlrev_b32 v3, 6, v3
    v_lshl_add_u32 v3, v2, 10, v3
    v_and_b32 v2, 3, v1
    v_lshl_add_u32 v9, v2, 4, v3
    s_and_b32 s29, s26, 7
    s_lshl_b32 s32, s24, 16
    s_lshl_b32 s33, s29, 7
    s_add_u32 s32, s32, s33
    s_and_b32 s33, s24, 3
    s_lshl_b32 s33, s33, 13
    s_lshr_b32 s34, s24, 2
    s_lshl_b32 s34, s34, 16
    s_add_u32 s33, s33, s34
    v_exp_f32 v44, v44
    v_exp_f32 v45, v45
    s_mov_b64 exec, s[36:37]
    ds_read_b128 v[32:35], v6 offset:1024
    ds_read_b128 v[36:39], v6 offset:1536
    s_mov_b64 exec, -1
    v_exp_f32 v46, v46
    v_exp_f32 v47, v47
    v_exp_f32 v48, v48
    v_exp_f32 v49, v49
    v_exp_f32 v50, v50
    s_waitcnt lgkmcnt(4)
    v_mfma_f32_32x32x16_bf16 v[60:75], v[20:23], v[12:15], v[92:107]
    ds_read_b128 v[16:19], v5 offset:2048
    s_add_u32 m0, s39, 24576
    s_add_u32 s41, s40, 24576
    buffer_load_dwordx4 v4, s[20:23], s41 offen lds
    s_add_u32 m0, s39, 90112
    s_add_u32 s41, s40, 2121728
    buffer_load_dwordx4 v4, s[20:23], s41 offen lds
    v_exp_f32 v51, v51
    v_cvt_pk_bf16_f32 v44, v44, v45
    v_cvt_pk_bf16_f32 v45, v46, v47
    v_cvt_pk_bf16_f32 v46, v48, v49
    v_cvt_pk_bf16_f32 v47, v50, v51
    v_exp_f32 v52, v52
    v_exp_f32 v53, v53
    v_exp_f32 v54, v54
    s_waitcnt lgkmcnt(3)
    v_mfma_f32_32x32x16_bf16 v[76:91], v[24:27], v[44:47], v[76:91]
    v_exp_f32 v55, v55
    v_exp_f32 v56, v56
    v_exp_f32 v57, v57
    v_exp_f32 v58, v58
    v_exp_f32 v59, v59
    v_cvt_pk_bf16_f32 v52, v52, v53
    v_cvt_pk_bf16_f32 v53, v54, v55
    v_cvt_pk_bf16_f32 v54, v56, v57
    v_cvt_pk_bf16_f32 v55, v58, v59
    v_exp_f32 v60, v60
    v_exp_f32 v61, v61
    v_mfma_f32_32x32x16_bf16 v[76:91], v[28:31], v[52:55], v[76:91]
    s_mov_b64 exec, s[36:37]
    ds_read_b128 v[24:27], v6 offset:2048
    ds_read_b128 v[28:31], v6 offset:2560
    s_mov_b64 exec, -1
    v_exp_f32 v62, v62
    v_exp_f32 v63, v63
    v_exp_f32 v64, v64
    v_exp_f32 v65, v65
    v_exp_f32 v66, v66
    s_waitcnt lgkmcnt(2)
    v_mfma_f32_32x32x16_bf16 v[44:59], v[16:19], v[12:15], v[92:107]
    s_add_u32 m0, s31, 0
    s_nop 0
    buffer_load_dwordx4 v7, s[48:51], s56 offen lds
    ds_read_b128 v[20:23], v5 offset:3072
    v_exp_f32 v67, v67
    v_cvt_pk_bf16_f32 v60, v60, v61
    v_cvt_pk_bf16_f32 v61, v62, v63
    v_cvt_pk_bf16_f32 v62, v64, v65
    v_cvt_pk_bf16_f32 v63, v66, v67
    v_exp_f32 v68, v68
    v_exp_f32 v69, v69
    v_exp_f32 v70, v70
    v_mfma_f32_32x32x16_bf16 v[76:91], v[32:35], v[60:63], v[76:91]
    v_exp_f32 v71, v71
    v_exp_f32 v72, v72
    v_exp_f32 v73, v73
    v_exp_f32 v74, v74
    v_exp_f32 v75, v75
    v_cvt_pk_bf16_f32 v68, v68, v69
    v_cvt_pk_bf16_f32 v69, v70, v71
    v_cvt_pk_bf16_f32 v70, v72, v73
    v_cvt_pk_bf16_f32 v71, v74, v75
    v_exp_f32 v44, v44
    v_exp_f32 v45, v45
    v_mfma_f32_32x32x16_bf16 v[76:91], v[36:39], v[68:71], v[76:91]
    s_mov_b64 exec, s[36:37]
    ds_read_b128 v[32:35], v6 offset:3072
    ds_read_b128 v[36:39], v6 offset:3584
    s_mov_b64 exec, -1
    v_exp_f32 v46, v46
    v_exp_f32 v47, v47
    v_exp_f32 v48, v48
    v_exp_f32 v49, v49
    v_exp_f32 v50, v50
    s_waitcnt lgkmcnt(2)
    v_mfma_f32_32x32x16_bf16 v[60:75], v[20:23], v[12:15], v[92:107]
    s_add_u32 m0, s31, 1024
    s_nop 0
    buffer_load_dwordx4 v8, s[52:55], s57 offen lds
    ds_read_b128 v[16:19], v5 offset:4096
    v_exp_f32 v51, v51
    v_cvt_pk_bf16_f32 v44, v44, v45
    v_cvt_pk_bf16_f32 v45, v46, v47
    v_cvt_pk_bf16_f32 v46, v48, v49
    v_cvt_pk_bf16_f32 v47, v50, v51
    v_exp_f32 v52, v52
    v_exp_f32 v53, v53
    v_exp_f32 v54, v54
    v_mfma_f32_32x32x16_bf16 v[76:91], v[24:27], v[44:47], v[76:91]
    v_exp_f32 v55, v55
    v_exp_f32 v56, v56
    v_exp_f32 v57, v57
    v_exp_f32 v58, v58
    v_exp_f32 v59, v59
    v_cvt_pk_bf16_f32 v52, v52, v53
    v_cvt_pk_bf16_f32 v53, v54, v55
    v_cvt_pk_bf16_f32 v54, v56, v57
    v_cvt_pk_bf16_f32 v55, v58, v59
    v_exp_f32 v60, v60
    v_exp_f32 v61, v61
    v_mfma_f32_32x32x16_bf16 v[76:91], v[28:31], v[52:55], v[76:91]
    s_mov_b64 exec, s[36:37]
    ds_read_b128 v[24:27], v6 offset:4096
    ds_read_b128 v[28:31], v6 offset:4608
    s_mov_b64 exec, -1
    v_exp_f32 v62, v62
    v_exp_f32 v63, v63
    v_exp_f32 v64, v64
    v_exp_f32 v65, v65
    v_exp_f32 v66, v66
    s_waitcnt lgkmcnt(2)
    v_mfma_f32_32x32x16_bf16 v[44:59], v[16:19], v[12:15], v[92:107]
    s_add_u32 m0, s31, 2048
    s_nop 0
    buffer_load_dwordx4 v7, s[48:51], s58 offen lds
    ds_read_b128 v[20:23], v5 offset:5120
    v_exp_f32 v67, v67
    v_cvt_pk_bf16_f32 v60, v60, v61
    v_cvt_pk_bf16_f32 v61, v62, v63
    v_cvt_pk_bf16_f32 v62, v64, v65
    v_cvt_pk_bf16_f32 v63, v66, v67
    v_exp_f32 v68, v68
    v_exp_f32 v69, v69
    v_exp_f32 v70, v70
    v_mfma_f32_32x32x16_bf16 v[76:91], v[32:35], v[60:63], v[76:91]
    v_exp_f32 v71, v71
    v_exp_f32 v72, v72
    v_exp_f32 v73, v73
    v_exp_f32 v74, v74
    v_exp_f32 v75, v75
    v_cvt_pk_bf16_f32 v68, v68, v69
    v_cvt_pk_bf16_f32 v69, v70, v71
    v_cvt_pk_bf16_f32 v70, v72, v73
    v_cvt_pk_bf16_f32 v71, v74, v75
    v_exp_f32 v44, v44
    v_exp_f32 v45, v45
    v_mfma_f32_32x32x16_bf16 v[76:91], v[36:39], v[68:71], v[76:91]
    s_mov_b64 exec, s[36:37]
    ds_read_b128 v[32:35], v6 offset:5120
    ds_read_b128 v[36:39], v6 offset:5632
    s_mov_b64 exec, -1
    v_exp_f32 v46, v46
    v_exp_f32 v47, v47
    v_exp_f32 v48, v48
    v_exp_f32 v49, v49
    v_exp_f32 v50, v50
    s_waitcnt lgkmcnt(2)
    v_mfma_f32_32x32x16_bf16 v[60:75], v[20:23], v[12:15], v[92:107]
    s_add_u32 m0, s31, 3072
    s_nop 0
    buffer_load_dwordx4 v8, s[52:55], s59 offen lds
    ds_read_b128 v[16:19], v5 offset:6144
    v_exp_f32 v51, v51
    v_cvt_pk_bf16_f32 v44, v44, v45
    v_cvt_pk_bf16_f32 v45, v46, v47
    v_cvt_pk_bf16_f32 v46, v48, v49
    v_cvt_pk_bf16_f32 v47, v50, v51
    v_exp_f32 v52, v52
    v_exp_f32 v53, v53
    v_exp_f32 v54, v54
    v_mfma_f32_32x32x16_bf16 v[76:91], v[24:27], v[44:47], v[76:91]
    v_exp_f32 v55, v55
    v_exp_f32 v56, v56
    v_exp_f32 v57, v57
    v_exp_f32 v58, v58
    v_exp_f32 v59, v59
    v_cvt_pk_bf16_f32 v52, v52, v53
    v_cvt_pk_bf16_f32 v53, v54, v55
    v_cvt_pk_bf16_f32 v54, v56, v57
    v_cvt_pk_bf16_f32 v55, v58, v59
    v_exp_f32 v60, v60
    v_exp_f32 v61, v61
    v_mfma_f32_32x32x16_bf16 v[76:91], v[28:31], v[52:55], v[76:91]
    s_mov_b64 exec, s[36:37]
    ds_read_b128 v[24:27], v6 offset:6144
    ds_read_b128 v[28:31], v6 offset:6656
    s_mov_b64 exec, -1
    v_exp_f32 v62, v62
    v_exp_f32 v63, v63
    v_exp_f32 v64, v64
    v_exp_f32 v65, v65
    v_exp_f32 v66, v66
    s_waitcnt lgkmcnt(2)
    v_mfma_f32_32x32x16_bf16 v[44:59], v[16:19], v[12:15], v[92:107]
    ds_read_b128 v[20:23], v5 offset:7168
    v_exp_f32 v67, v67
    v_cvt_pk_bf16_f32 v60, v60, v61
    v_cvt_pk_bf16_f32 v61, v62, v63
    v_cvt_pk_bf16_f32 v62, v64, v65
    v_cvt_pk_bf16_f32 v63, v66, v67
    v_exp_f32 v68, v68
    v_exp_f32 v69, v69
    v_exp_f32 v70, v70
    v_mfma_f32_32x32x16_bf16 v[76:91], v[32:35], v[60:63], v[76:91]
    v_exp_f32 v71, v71
    v_exp_f32 v72, v72
    v_exp_f32 v73, v73
    v_exp_f32 v74, v74
    v_exp_f32 v75, v75
    v_cvt_pk_bf16_f32 v68, v68, v69
    v_cvt_pk_bf16_f32 v69, v70, v71
    v_cvt_pk_bf16_f32 v70, v72, v73
    v_cvt_pk_bf16_f32 v71, v74, v75
    v_exp_f32 v44, v44
    v_exp_f32 v45, v45
    v_mfma_f32_32x32x16_bf16 v[76:91], v[36:39], v[68:71], v[76:91]
    s_mov_b64 exec, s[36:37]
    ds_read_b128 v[32:35], v6 offset:7168
    ds_read_b128 v[36:39], v6 offset:7680
    s_mov_b64 exec, -1
    v_exp_f32 v46, v46
    v_exp_f32 v47, v47
    v_exp_f32 v48, v48
    v_exp_f32 v49, v49
    v_exp_f32 v50, v50
    s_waitcnt lgkmcnt(2)
    v_mfma_f32_32x32x16_bf16 v[60:75], v[20:23], v[12:15], v[92:107]
    s_waitcnt vmcnt(8)
    s_barrier
    ds_read_b128 v[16:19], v5 offset:8192
    v_exp_f32 v51, v51
    v_cvt_pk_bf16_f32 v44, v44, v45
    v_cvt_pk_bf16_f32 v45, v46, v47
    v_cvt_pk_bf16_f32 v46, v48, v49
    v_cvt_pk_bf16_f32 v47, v50, v51
    v_exp_f32 v52, v52
    v_exp_f32 v53, v53
    v_exp_f32 v54, v54
    v_mfma_f32_32x32x16_bf16 v[76:91], v[24:27], v[44:47], v[76:91]
    v_exp_f32 v55, v55
    v_exp_f32 v56, v56
    v_exp_f32 v57, v57
    v_exp_f32 v58, v58
    v_exp_f32 v59, v59
    v_cvt_pk_bf16_f32 v52, v52, v53
    v_cvt_pk_bf16_f32 v53, v54, v55
    v_cvt_pk_bf16_f32 v54, v56, v57
    v_cvt_pk_bf16_f32 v55, v58, v59
    v_exp_f32 v60, v60
    v_exp_f32 v61, v61
    v_mfma_f32_32x32x16_bf16 v[76:91], v[28:31], v[52:55], v[76:91]
    s_mov_b64 exec, s[36:37]
    ds_read_b128 v[24:27], v6 offset:8192
    ds_read_b128 v[28:31], v6 offset:8704
    s_mov_b64 exec, -1
    v_exp_f32 v62, v62
    v_exp_f32 v63, v63
    v_exp_f32 v64, v64
    v_exp_f32 v65, v65
    v_exp_f32 v66, v66
    s_waitcnt lgkmcnt(2)
    v_mfma_f32_32x32x16_bf16 v[44:59], v[16:19], v[12:15], v[92:107]
    ds_read_b128 v[20:23], v5 offset:9216
    v_exp_f32 v67, v67
    v_cvt_pk_bf16_f32 v60, v60, v61
    v_cvt_pk_bf16_f32 v61, v62, v63
    v_cvt_pk_bf16_f32 v62, v64, v65
    v_cvt_pk_bf16_f32 v63, v66, v67
    v_exp_f32 v68, v68
    v_exp_f32 v69, v69
    v_exp_f32 v70, v70
    v_mfma_f32_32x32x16_bf16 v[76:91], v[32:35], v[60:63], v[76:91]
    v_exp_f32 v71, v71
    v_exp_f32 v72, v72
    v_exp_f32 v73, v73
    v_exp_f32 v74, v74
    v_exp_f32 v75, v75
    v_cvt_pk_bf16_f32 v68, v68, v69
    v_cvt_pk_bf16_f32 v69, v70, v71
    v_cvt_pk_bf16_f32 v70, v72, v73
    v_cvt_pk_bf16_f32 v71, v74, v75
    v_exp_f32 v44, v44
    v_exp_f32 v45, v45
    v_mfma_f32_32x32x16_bf16 v[76:91], v[36:39], v[68:71], v[76:91]
    s_mov_b64 exec, s[36:37]
    ds_read_b128 v[32:35], v6 offset:9216
    ds_read_b128 v[36:39], v6 offset:9728
    s_mov_b64 exec, -1
    v_exp_f32 v46, v46
    v_exp_f32 v47, v47
    v_exp_f32 v48, v48
    v_exp_f32 v49, v49
    v_exp_f32 v50, v50
    s_waitcnt lgkmcnt(2)
    v_mfma_f32_32x32x16_bf16 v[60:75], v[20:23], v[12:15], v[92:107]
    ds_read_b128 v[16:19], v5 offset:10240
    s_add_u32 m0, s39, 32768
    s_add_u32 s41, s40, 32768
    buffer_load_dwordx4 v4, s[20:23], s41 offen lds
    s_add_u32 m0, s39, 98304
    s_add_u32 s41, s40, 2129920
    buffer_load_dwordx4 v4, s[20:23], s41 offen lds
    v_exp_f32 v51, v51
    v_cvt_pk_bf16_f32 v44, v44, v45
    v_cvt_pk_bf16_f32 v45, v46, v47
    v_cvt_pk_bf16_f32 v46, v48, v49
    v_cvt_pk_bf16_f32 v47, v50, v51
    v_exp_f32 v52, v52
    v_exp_f32 v53, v53
    v_exp_f32 v54, v54
    v_mfma_f32_32x32x16_bf16 v[76:91], v[24:27], v[44:47], v[76:91]
    v_exp_f32 v55, v55
    v_exp_f32 v56, v56
    v_exp_f32 v57, v57
    v_exp_f32 v58, v58
    v_exp_f32 v59, v59
    v_cvt_pk_bf16_f32 v52, v52, v53
    v_cvt_pk_bf16_f32 v53, v54, v55
    v_cvt_pk_bf16_f32 v54, v56, v57
    v_cvt_pk_bf16_f32 v55, v58, v59
    v_exp_f32 v60, v60
    v_exp_f32 v61, v61
    v_mfma_f32_32x32x16_bf16 v[76:91], v[28:31], v[52:55], v[76:91]
    s_mov_b64 exec, s[36:37]
    ds_read_b128 v[24:27], v6 offset:10240
    ds_read_b128 v[28:31], v6 offset:10752
    s_mov_b64 exec, -1
    v_exp_f32 v62, v62
    v_exp_f32 v63, v63
    v_exp_f32 v64, v64
    v_exp_f32 v65, v65
    v_exp_f32 v66, v66
    s_waitcnt lgkmcnt(2)
    v_mfma_f32_32x32x16_bf16 v[44:59], v[16:19], v[12:15], v[92:107]
    ds_read_b128 v[20:23], v5 offset:11264
    v_exp_f32 v67, v67
    v_cvt_pk_bf16_f32 v60, v60, v61
    v_cvt_pk_bf16_f32 v61, v62, v63
    v_cvt_pk_bf16_f32 v62, v64, v65
    v_cvt_pk_bf16_f32 v63, v66, v67
    v_exp_f32 v68, v68
    v_exp_f32 v69, v69
    v_exp_f32 v70, v70
    v_mfma_f32_32x32x16_bf16 v[76:91], v[32:35], v[60:63], v[76:91]
    v_exp_f32 v71, v71
    v_exp_f32 v72, v72
    v_exp_f32 v73, v73
    v_exp_f32 v74, v74
    v_exp_f32 v75, v75
    v_cvt_pk_bf16_f32 v68, v68, v69
    v_cvt_pk_bf16_f32 v69, v70, v71
    v_cvt_pk_bf16_f32 v70, v72, v73
    v_cvt_pk_bf16_f32 v71, v74, v75
    v_exp_f32 v44, v44
    v_exp_f32 v45, v45
    v_mfma_f32_32x32x16_bf16 v[76:91], v[36:39], v[68:71], v[76:91]
    s_mov_b64 exec, s[36:37]
    ds_read_b128 v[32:35], v6 offset:11264
    ds_read_b128 v[36:39], v6 offset:11776
    s_mov_b64 exec, -1
    v_exp_f32 v46, v46
    v_exp_f32 v47, v47
    v_exp_f32 v48, v48
    v_exp_f32 v49, v49
    v_exp_f32 v50, v50
    s_waitcnt lgkmcnt(2)
    v_mfma_f32_32x32x16_bf16 v[60:75], v[20:23], v[12:15], v[92:107]
    ds_read_b128 v[16:19], v5 offset:12288
    v_exp_f32 v51, v51
    v_cvt_pk_bf16_f32 v44, v44, v45
    v_cvt_pk_bf16_f32 v45, v46, v47
    v_cvt_pk_bf16_f32 v46, v48, v49
    v_cvt_pk_bf16_f32 v47, v50, v51
    v_exp_f32 v52, v52
    v_exp_f32 v53, v53
    v_exp_f32 v54, v54
    v_mfma_f32_32x32x16_bf16 v[76:91], v[24:27], v[44:47], v[76:91]
    v_exp_f32 v55, v55
    v_exp_f32 v56, v56
    v_exp_f32 v57, v57
    v_exp_f32 v58, v58
    v_exp_f32 v59, v59
    v_cvt_pk_bf16_f32 v52, v52, v53
    v_cvt_pk_bf16_f32 v53, v54, v55
    v_cvt_pk_bf16_f32 v54, v56, v57
    v_cvt_pk_bf16_f32 v55, v58, v59
    v_exp_f32 v60, v60
    v_exp_f32 v61, v61
    v_mfma_f32_32x32x16_bf16 v[76:91], v[28:31], v[52:55], v[76:91]
    s_mov_b64 exec, s[36:37]
    ds_read_b128 v[24:27], v6 offset:12288
    ds_read_b128 v[28:31], v6 offset:12800
    s_mov_b64 exec, -1
    v_exp_f32 v62, v62
    v_exp_f32 v63, v63
    v_exp_f32 v64, v64
    v_exp_f32 v65, v65
    v_exp_f32 v66, v66
    s_waitcnt lgkmcnt(2)
    v_mfma_f32_32x32x16_bf16 v[44:59], v[16:19], v[12:15], v[92:107]
    ds_read_b128 v[20:23], v5 offset:13312
    v_exp_f32 v67, v67
    v_cvt_pk_bf16_f32 v60, v60, v61
    v_cvt_pk_bf16_f32 v61, v62, v63
    v_cvt_pk_bf16_f32 v62, v64, v65
    v_cvt_pk_bf16_f32 v63, v66, v67
    v_exp_f32 v68, v68
    v_exp_f32 v69, v69
    v_exp_f32 v70, v70
    v_mfma_f32_32x32x16_bf16 v[76:91], v[32:35], v[60:63], v[76:91]
    v_exp_f32 v71, v71
    v_exp_f32 v72, v72
    v_exp_f32 v73, v73
    v_exp_f32 v74, v74
    v_exp_f32 v75, v75
    v_cvt_pk_bf16_f32 v68, v68, v69
    v_cvt_pk_bf16_f32 v69, v70, v71
    v_cvt_pk_bf16_f32 v70, v72, v73
    v_cvt_pk_bf16_f32 v71, v74, v75
    v_exp_f32 v44, v44
    v_exp_f32 v45, v45
    v_mfma_f32_32x32x16_bf16 v[76:91], v[36:39], v[68:71], v[76:91]
    s_mov_b64 exec, s[36:37]
    ds_read_b128 v[32:35], v6 offset:13312
    ds_read_b128 v[36:39], v6 offset:13824
    s_mov_b64 exec, -1
    v_exp_f32 v46, v46
    v_exp_f32 v47, v47
    v_exp_f32 v48, v48
    v_exp_f32 v49, v49
    v_exp_f32 v50, v50
    s_waitcnt lgkmcnt(2)
    v_mfma_f32_32x32x16_bf16 v[60:75], v[20:23], v[12:15], v[92:107]
    s_waitcnt vmcnt(2)
    ds_read_b64_tr_b16 a[0:1], v124 offset:0
    ds_read_b64_tr_b16 a[2:3], v124 offset:2048
    ds_read_b64_tr_b16 a[4:5], v125 offset:0
    ds_read_b64_tr_b16 a[6:7], v125 offset:2048
    ds_read_b64_tr_b16 a[8:9], v126 offset:0
    ds_read_b64_tr_b16 a[10:11], v126 offset:2048
    ds_read_b64_tr_b16 a[12:13], v127 offset:0
    ds_read_b64_tr_b16 a[14:15], v127 offset:2048
    ds_read_b128 v[16:19], v5 offset:14336
    v_exp_f32 v51, v51
    v_cvt_pk_bf16_f32 v44, v44, v45
    v_cvt_pk_bf16_f32 v45, v46, v47
    v_cvt_pk_bf16_f32 v46, v48, v49
    v_cvt_pk_bf16_f32 v47, v50, v51
    v_exp_f32 v52, v52
    v_exp_f32 v53, v53
    v_exp_f32 v54, v54
    v_mfma_f32_32x32x16_bf16 v[76:91], v[24:27], v[44:47], v[76:91]
    v_exp_f32 v55, v55
    v_exp_f32 v56, v56
    v_exp_f32 v57, v57
    v_exp_f32 v58, v58
    v_exp_f32 v59, v59
    v_cvt_pk_bf16_f32 v52, v52, v53
    v_cvt_pk_bf16_f32 v53, v54, v55
    v_cvt_pk_bf16_f32 v54, v56, v57
    v_cvt_pk_bf16_f32 v55, v58, v59
    v_exp_f32 v60, v60
    v_exp_f32 v61, v61
    v_mfma_f32_32x32x16_bf16 v[76:91], v[28:31], v[52:55], v[76:91]
    s_mov_b64 exec, s[36:37]
    ds_read_b128 v[24:27], v6 offset:14336
    ds_read_b128 v[28:31], v6 offset:14848
    s_mov_b64 exec, -1
    v_exp_f32 v62, v62
    v_exp_f32 v63, v63
    v_exp_f32 v64, v64
    v_exp_f32 v65, v65
    v_exp_f32 v66, v66
    s_waitcnt lgkmcnt(2)
    v_mfma_f32_32x32x16_bf16 v[44:59], v[16:19], v[12:15], v[92:107]
    buffer_store_dwordx4 a[0:3], v4, s[20:23], s60 offen sc1
    ds_read_b128 v[20:23], v5 offset:15360
    v_exp_f32 v67, v67
    v_cvt_pk_bf16_f32 v60, v60, v61
    v_cvt_pk_bf16_f32 v61, v62, v63
    v_cvt_pk_bf16_f32 v62, v64, v65
    v_cvt_pk_bf16_f32 v63, v66, v67
    v_exp_f32 v68, v68
    v_exp_f32 v69, v69
    v_exp_f32 v70, v70
    v_mfma_f32_32x32x16_bf16 v[76:91], v[32:35], v[60:63], v[76:91]
    v_exp_f32 v71, v71
    v_exp_f32 v72, v72
    v_exp_f32 v73, v73
    v_exp_f32 v74, v74
    v_exp_f32 v75, v75
    v_cvt_pk_bf16_f32 v68, v68, v69
    v_cvt_pk_bf16_f32 v69, v70, v71
    v_cvt_pk_bf16_f32 v70, v72, v73
    v_cvt_pk_bf16_f32 v71, v74, v75
    v_exp_f32 v44, v44
    v_exp_f32 v45, v45
    v_mfma_f32_32x32x16_bf16 v[76:91], v[36:39], v[68:71], v[76:91]
    s_mov_b64 exec, s[36:37]
    ds_read_b128 v[32:35], v6 offset:15360
    ds_read_b128 v[36:39], v6 offset:15872
    s_mov_b64 exec, -1
    v_exp_f32 v46, v46
    v_exp_f32 v47, v47
    v_exp_f32 v48, v48
    v_exp_f32 v49, v49
    v_exp_f32 v50, v50
    s_waitcnt lgkmcnt(2)
    v_mfma_f32_32x32x16_bf16 v[60:75], v[20:23], v[12:15], v[92:107]
    s_waitcnt vmcnt(9)
    s_barrier
    buffer_store_dwordx4 a[4:7], v4, s[20:23], s61 offen sc1
    ds_read_b128 v[16:19], v5 offset:16384
    v_exp_f32 v51, v51
    v_cvt_pk_bf16_f32 v44, v44, v45
    v_cvt_pk_bf16_f32 v45, v46, v47
    v_cvt_pk_bf16_f32 v46, v48, v49
    v_cvt_pk_bf16_f32 v47, v50, v51
    v_exp_f32 v52, v52
    v_exp_f32 v53, v53
    v_exp_f32 v54, v54
    v_mfma_f32_32x32x16_bf16 v[76:91], v[24:27], v[44:47], v[76:91]
    v_exp_f32 v55, v55
    v_exp_f32 v56, v56
    v_exp_f32 v57, v57
    v_exp_f32 v58, v58
    v_exp_f32 v59, v59
    v_cvt_pk_bf16_f32 v52, v52, v53
    v_cvt_pk_bf16_f32 v53, v54, v55
    v_cvt_pk_bf16_f32 v54, v56, v57
    v_cvt_pk_bf16_f32 v55, v58, v59
    v_exp_f32 v60, v60
    v_exp_f32 v61, v61
    v_mfma_f32_32x32x16_bf16 v[76:91], v[28:31], v[52:55], v[76:91]
    s_mov_b64 exec, s[36:37]
    ds_read_b128 v[24:27], v6 offset:16384
    ds_read_b128 v[28:31], v6 offset:16896
    s_mov_b64 exec, -1
    v_exp_f32 v62, v62
    v_exp_f32 v63, v63
    v_exp_f32 v64, v64
    v_exp_f32 v65, v65
    v_exp_f32 v66, v66
    s_waitcnt lgkmcnt(2)
    v_mfma_f32_32x32x16_bf16 v[44:59], v[16:19], v[12:15], v[92:107]
    buffer_store_dwordx4 a[8:11], v4, s[20:23], s62 offen sc1
    ds_read_b128 v[20:23], v5 offset:17408
    v_exp_f32 v67, v67
    v_cvt_pk_bf16_f32 v60, v60, v61
    v_cvt_pk_bf16_f32 v61, v62, v63
    v_cvt_pk_bf16_f32 v62, v64, v65
    v_cvt_pk_bf16_f32 v63, v66, v67
    v_exp_f32 v68, v68
    v_exp_f32 v69, v69
    v_exp_f32 v70, v70
    v_mfma_f32_32x32x16_bf16 v[76:91], v[32:35], v[60:63], v[76:91]
    v_exp_f32 v71, v71
    v_exp_f32 v72, v72
    v_exp_f32 v73, v73
    v_exp_f32 v74, v74
    v_exp_f32 v75, v75
    v_cvt_pk_bf16_f32 v68, v68, v69
    v_cvt_pk_bf16_f32 v69, v70, v71
    v_cvt_pk_bf16_f32 v70, v72, v73
    v_cvt_pk_bf16_f32 v71, v74, v75
    v_exp_f32 v44, v44
    v_exp_f32 v45, v45
    v_mfma_f32_32x32x16_bf16 v[76:91], v[36:39], v[68:71], v[76:91]
    s_mov_b64 exec, s[36:37]
    ds_read_b128 v[32:35], v6 offset:17408
    ds_read_b128 v[36:39], v6 offset:17920
    s_mov_b64 exec, -1
    v_exp_f32 v46, v46
    v_exp_f32 v47, v47
    v_exp_f32 v48, v48
    v_exp_f32 v49, v49
    v_exp_f32 v50, v50
    s_waitcnt lgkmcnt(2)
    v_mfma_f32_32x32x16_bf16 v[60:75], v[20:23], v[12:15], v[92:107]
    buffer_store_dwordx4 a[12:15], v4, s[20:23], s63 offen sc1
    ds_read_b128 v[16:19], v5 offset:18432
    s_add_u32 m0, s39, 40960
    s_add_u32 s41, s40, 40960
    buffer_load_dwordx4 v4, s[20:23], s41 offen lds
    s_add_u32 m0, s39, 106496
    s_add_u32 s41, s40, 2138112
    buffer_load_dwordx4 v4, s[20:23], s41 offen lds
    v_exp_f32 v51, v51
    v_cvt_pk_bf16_f32 v44, v44, v45
    v_cvt_pk_bf16_f32 v45, v46, v47
    v_cvt_pk_bf16_f32 v46, v48, v49
    v_cvt_pk_bf16_f32 v47, v50, v51
    v_exp_f32 v52, v52
    v_exp_f32 v53, v53
    v_exp_f32 v54, v54
    v_mfma_f32_32x32x16_bf16 v[76:91], v[24:27], v[44:47], v[76:91]
    v_exp_f32 v55, v55
    v_exp_f32 v56, v56
    v_exp_f32 v57, v57
    v_exp_f32 v58, v58
    v_exp_f32 v59, v59
    v_cvt_pk_bf16_f32 v52, v52, v53
    v_cvt_pk_bf16_f32 v53, v54, v55
    v_cvt_pk_bf16_f32 v54, v56, v57
    v_cvt_pk_bf16_f32 v55, v58, v59
    v_exp_f32 v60, v60
    v_exp_f32 v61, v61
    v_mfma_f32_32x32x16_bf16 v[76:91], v[28:31], v[52:55], v[76:91]
    s_mov_b64 exec, s[36:37]
    ds_read_b128 v[24:27], v6 offset:18432
    ds_read_b128 v[28:31], v6 offset:18944
    s_mov_b64 exec, -1
    v_exp_f32 v62, v62
    v_exp_f32 v63, v63
    v_exp_f32 v64, v64
    v_exp_f32 v65, v65
    v_exp_f32 v66, v66
    s_waitcnt lgkmcnt(2)
    v_mfma_f32_32x32x16_bf16 v[44:59], v[16:19], v[12:15], v[92:107]
    ds_read_b128 v[20:23], v5 offset:19456
    v_exp_f32 v67, v67
    v_cvt_pk_bf16_f32 v60, v60, v61
    v_cvt_pk_bf16_f32 v61, v62, v63
    v_cvt_pk_bf16_f32 v62, v64, v65
    v_cvt_pk_bf16_f32 v63, v66, v67
    v_exp_f32 v68, v68
    v_exp_f32 v69, v69
    v_exp_f32 v70, v70
    v_mfma_f32_32x32x16_bf16 v[76:91], v[32:35], v[60:63], v[76:91]
    v_exp_f32 v71, v71
    v_exp_f32 v72, v72
    v_exp_f32 v73, v73
    v_exp_f32 v74, v74
    v_exp_f32 v75, v75
    v_cvt_pk_bf16_f32 v68, v68, v69
    v_cvt_pk_bf16_f32 v69, v70, v71
    v_cvt_pk_bf16_f32 v70, v72, v73
    v_cvt_pk_bf16_f32 v71, v74, v75
    v_exp_f32 v44, v44
    v_exp_f32 v45, v45
    v_mfma_f32_32x32x16_bf16 v[76:91], v[36:39], v[68:71], v[76:91]
    s_mov_b64 exec, s[36:37]
    ds_read_b128 v[32:35], v6 offset:19456
    ds_read_b128 v[36:39], v6 offset:19968
    s_mov_b64 exec, -1
    v_exp_f32 v46, v46
    v_exp_f32 v47, v47
    v_exp_f32 v48, v48
    v_exp_f32 v49, v49
    v_exp_f32 v50, v50
    s_waitcnt lgkmcnt(2)
    v_mfma_f32_32x32x16_bf16 v[60:75], v[20:23], v[12:15], v[92:107]
    ds_read_b128 v[16:19], v5 offset:20480
    v_exp_f32 v51, v51
    v_cvt_pk_bf16_f32 v44, v44, v45
    v_cvt_pk_bf16_f32 v45, v46, v47
    v_cvt_pk_bf16_f32 v46, v48, v49
    v_cvt_pk_bf16_f32 v47, v50, v51
    v_exp_f32 v52, v52
    v_exp_f32 v53, v53
    v_exp_f32 v54, v54
    v_mfma_f32_32x32x16_bf16 v[76:91], v[24:27], v[44:47], v[76:91]
    v_exp_f32 v55, v55
    v_exp_f32 v56, v56
    v_exp_f32 v57, v57
    v_exp_f32 v58, v58
    v_exp_f32 v59, v59
    v_cvt_pk_bf16_f32 v52, v52, v53
    v_cvt_pk_bf16_f32 v53, v54, v55
    v_cvt_pk_bf16_f32 v54, v56, v57
    v_cvt_pk_bf16_f32 v55, v58, v59
    v_exp_f32 v60, v60
    v_exp_f32 v61, v61
    v_mfma_f32_32x32x16_bf16 v[76:91], v[28:31], v[52:55], v[76:91]
    s_mov_b64 exec, s[36:37]
    ds_read_b128 v[24:27], v6 offset:20480
    ds_read_b128 v[28:31], v6 offset:20992
    s_mov_b64 exec, -1
    v_exp_f32 v62, v62
    v_exp_f32 v63, v63
    v_exp_f32 v64, v64
    v_exp_f32 v65, v65
    v_exp_f32 v66, v66
    s_waitcnt lgkmcnt(2)
    v_mfma_f32_32x32x16_bf16 v[44:59], v[16:19], v[12:15], v[92:107]
    ds_read_b128 v[20:23], v5 offset:21504
    v_exp_f32 v67, v67
    v_cvt_pk_bf16_f32 v60, v60, v61
    v_cvt_pk_bf16_f32 v61, v62, v63
    v_cvt_pk_bf16_f32 v62, v64, v65
    v_cvt_pk_bf16_f32 v63, v66, v67
    v_exp_f32 v68, v68
    v_exp_f32 v69, v69
    v_exp_f32 v70, v70
    v_mfma_f32_32x32x16_bf16 v[76:91], v[32:35], v[60:63], v[76:91]
    v_exp_f32 v71, v71
    v_exp_f32 v72, v72
    v_exp_f32 v73, v73
    v_exp_f32 v74, v74
    v_exp_f32 v75, v75
    v_cvt_pk_bf16_f32 v68, v68, v69
    v_cvt_pk_bf16_f32 v69, v70, v71
    v_cvt_pk_bf16_f32 v70, v72, v73
    v_cvt_pk_bf16_f32 v71, v74, v75
    v_exp_f32 v44, v44
    v_exp_f32 v45, v45
    v_mfma_f32_32x32x16_bf16 v[76:91], v[36:39], v[68:71], v[76:91]
    s_mov_b64 exec, s[36:37]
    ds_read_b128 v[32:35], v6 offset:21504
    ds_read_b128 v[36:39], v6 offset:22016
    s_mov_b64 exec, -1
    v_exp_f32 v46, v46
    v_exp_f32 v47, v47
    v_exp_f32 v48, v48
    v_exp_f32 v49, v49
    v_exp_f32 v50, v50
    s_waitcnt lgkmcnt(2)
    v_mfma_f32_32x32x16_bf16 v[60:75], v[20:23], v[12:15], v[92:107]
    ds_read_b128 v[16:19], v5 offset:22528
    v_exp_f32 v51, v51
    v_cvt_pk_bf16_f32 v44, v44, v45
    v_cvt_pk_bf16_f32 v45, v46, v47
    v_cvt_pk_bf16_f32 v46, v48, v49
    v_cvt_pk_bf16_f32 v47, v50, v51
    v_exp_f32 v52, v52
    v_exp_f32 v53, v53
    v_exp_f32 v54, v54
    v_mfma_f32_32x32x16_bf16 v[76:91], v[24:27], v[44:47], v[76:91]
    v_exp_f32 v55, v55
    v_exp_f32 v56, v56
    v_exp_f32 v57, v57
    v_exp_f32 v58, v58
    v_exp_f32 v59, v59
    v_cvt_pk_bf16_f32 v52, v52, v53
    v_cvt_pk_bf16_f32 v53, v54, v55
    v_cvt_pk_bf16_f32 v54, v56, v57
    v_cvt_pk_bf16_f32 v55, v58, v59
    v_exp_f32 v60, v60
    v_exp_f32 v61, v61
    v_mfma_f32_32x32x16_bf16 v[76:91], v[28:31], v[52:55], v[76:91]
    s_mov_b64 exec, s[36:37]
    ds_read_b128 v[24:27], v6 offset:22528
    ds_read_b128 v[28:31], v6 offset:23040
    s_mov_b64 exec, -1
    v_exp_f32 v62, v62
    v_exp_f32 v63, v63
    v_exp_f32 v64, v64
    v_exp_f32 v65, v65
    v_exp_f32 v66, v66
    s_waitcnt lgkmcnt(2)
    v_mfma_f32_32x32x16_bf16 v[44:59], v[16:19], v[12:15], v[92:107]
    ds_read_b128 v[20:23], v5 offset:23552
    v_exp_f32 v67, v67
    v_cvt_pk_bf16_f32 v60, v60, v61
    v_cvt_pk_bf16_f32 v61, v62, v63
    v_cvt_pk_bf16_f32 v62, v64, v65
    v_cvt_pk_bf16_f32 v63, v66, v67
    v_exp_f32 v68, v68
    v_exp_f32 v69, v69
    v_exp_f32 v70, v70
    v_mfma_f32_32x32x16_bf16 v[76:91], v[32:35], v[60:63], v[76:91]
    v_exp_f32 v71, v71
    v_exp_f32 v72, v72
    v_exp_f32 v73, v73
    v_exp_f32 v74, v74
    v_exp_f32 v75, v75
    v_cvt_pk_bf16_f32 v68, v68, v69
    v_cvt_pk_bf16_f32 v69, v70, v71
    v_cvt_pk_bf16_f32 v70, v72, v73
    v_cvt_pk_bf16_f32 v71, v74, v75
    v_exp_f32 v44, v44
    v_exp_f32 v45, v45
    v_mfma_f32_32x32x16_bf16 v[76:91], v[36:39], v[68:71], v[76:91]
    s_mov_b64 exec, s[36:37]
    ds_read_b128 v[32:35], v6 offset:23552
    ds_read_b128 v[36:39], v6 offset:24064
    s_mov_b64 exec, -1
    v_exp_f32 v46, v46
    v_exp_f32 v47, v47
    v_exp_f32 v48, v48
    v_exp_f32 v49, v49
    v_exp_f32 v50, v50
    s_waitcnt lgkmcnt(2)
    v_mfma_f32_32x32x16_bf16 v[60:75], v[20:23], v[12:15], v[92:107]
    s_waitcnt vmcnt(12)
    s_waitcnt vmcnt(2)
    s_barrier
    s_cmp_lg_u32 s24, 0
    s_cbranch_scc1 f_f0a0
    s_lshl_b32 s41, s2, 2
    s_add_u32 s41, s41, 18226176
    v_mov_b32 v2, 0
    v_mov_b32 v3, 1
    s_mov_b64 exec, 1
    buffer_store_dword v3, v2, s[20:23], s41 offen sc1
    s_mov_b64 exec, -1
f_f0a0:
    ds_read_b128 v[16:19], v5 offset:24576
    v_exp_f32 v51, v51
    v_cvt_pk_bf16_f32 v44, v44, v45
    v_cvt_pk_bf16_f32 v45, v46, v47
    v_cvt_pk_bf16_f32 v46, v48, v49
    v_cvt_pk_bf16_f32 v47, v50, v51
    v_exp_f32 v52, v52
    v_exp_f32 v53, v53
    v_exp_f32 v54, v54
    v_mfma_f32_32x32x16_bf16 v[76:91], v[24:27], v[44:47], v[76:91]
    v_exp_f32 v55, v55
    v_exp_f32 v56, v56
    v_exp_f32 v57, v57
    v_exp_f32 v58, v58
    v_exp_f32 v59, v59
    v_cvt_pk_bf16_f32 v52, v52, v53
    v_cvt_pk_bf16_f32 v53, v54, v55
    v_cvt_pk_bf16_f32 v54, v56, v57
    v_cvt_pk_bf16_f32 v55, v58, v59
    v_exp_f32 v60, v60
    v_exp_f32 v61, v61
    v_mfma_f32_32x32x16_bf16 v[76:91], v[28:31], v[52:55], v[76:91]
    s_mov_b64 exec, s[36:37]
    ds_read_b128 v[24:27], v6 offset:24576
    ds_read_b128 v[28:31], v6 offset:25088
    s_mov_b64 exec, -1
    v_exp_f32 v62, v62
    v_exp_f32 v63, v63
    v_exp_f32 v64, v64
    v_exp_f32 v65, v65
    v_exp_f32 v66, v66
    s_waitcnt lgkmcnt(2)
    v_mfma_f32_32x32x16_bf16 v[44:59], v[16:19], v[12:15], v[92:107]
    ds_read_b128 v[20:23], v5 offset:25600
    v_exp_f32 v67, v67
    v_cvt_pk_bf16_f32 v60, v60, v61
    v_cvt_pk_bf16_f32 v61, v62, v63
    v_cvt_pk_bf16_f32 v62, v64, v65
    v_cvt_pk_bf16_f32 v63, v66, v67
    v_exp_f32 v68, v68
    v_exp_f32 v69, v69
    v_exp_f32 v70, v70
    v_mfma_f32_32x32x16_bf16 v[76:91], v[32:35], v[60:63], v[76:91]
    v_exp_f32 v71, v71
    v_exp_f32 v72, v72
    v_exp_f32 v73, v73
    v_exp_f32 v74, v74
    v_exp_f32 v75, v75
    v_cvt_pk_bf16_f32 v68, v68, v69
    v_cvt_pk_bf16_f32 v69, v70, v71
    v_cvt_pk_bf16_f32 v70, v72, v73
    v_cvt_pk_bf16_f32 v71, v74, v75
    v_exp_f32 v44, v44
    v_exp_f32 v45, v45
    v_mfma_f32_32x32x16_bf16 v[76:91], v[36:39], v[68:71], v[76:91]
    s_mov_b64 exec, s[36:37]
    ds_read_b128 v[32:35], v6 offset:25600
    ds_read_b128 v[36:39], v6 offset:26112
    s_mov_b64 exec, -1
    v_exp_f32 v46, v46
    v_exp_f32 v47, v47
    v_exp_f32 v48, v48
    v_exp_f32 v49, v49
    v_exp_f32 v50, v50
    s_waitcnt lgkmcnt(2)
    v_mfma_f32_32x32x16_bf16 v[60:75], v[20:23], v[12:15], v[92:107]
    ds_read_b128 v[16:19], v5 offset:26624
    s_add_u32 m0, s39, 49152
    s_add_u32 s41, s40, 49152
    buffer_load_dwordx4 v4, s[20:23], s41 offen lds
    s_add_u32 m0, s39, 114688
    s_add_u32 s41, s40, 2146304
    buffer_load_dwordx4 v4, s[20:23], s41 offen lds
    v_exp_f32 v51, v51
    v_cvt_pk_bf16_f32 v44, v44, v45
    v_cvt_pk_bf16_f32 v45, v46, v47
    v_cvt_pk_bf16_f32 v46, v48, v49
    v_cvt_pk_bf16_f32 v47, v50, v51
    v_exp_f32 v52, v52
    v_exp_f32 v53, v53
    v_exp_f32 v54, v54
    v_mfma_f32_32x32x16_bf16 v[76:91], v[24:27], v[44:47], v[76:91]
    v_exp_f32 v55, v55
    v_exp_f32 v56, v56
    v_exp_f32 v57, v57
    v_exp_f32 v58, v58
    v_exp_f32 v59, v59
    v_cvt_pk_bf16_f32 v52, v52, v53
    v_cvt_pk_bf16_f32 v53, v54, v55
    v_cvt_pk_bf16_f32 v54, v56, v57
    v_cvt_pk_bf16_f32 v55, v58, v59
    v_exp_f32 v60, v60
    v_exp_f32 v61, v61
    v_mfma_f32_32x32x16_bf16 v[76:91], v[28:31], v[52:55], v[76:91]
    s_mov_b64 exec, s[36:37]
    ds_read_b128 v[24:27], v6 offset:26624
    ds_read_b128 v[28:31], v6 offset:27136
    s_mov_b64 exec, -1
    v_exp_f32 v62, v62
    v_exp_f32 v63, v63
    v_exp_f32 v64, v64
    v_exp_f32 v65, v65
    v_exp_f32 v66, v66
    s_waitcnt lgkmcnt(2)
    v_mfma_f32_32x32x16_bf16 v[44:59], v[16:19], v[12:15], v[92:107]
    ds_read_b128 v[20:23], v5 offset:27648
    v_exp_f32 v67, v67
    v_cvt_pk_bf16_f32 v60, v60, v61
    v_cvt_pk_bf16_f32 v61, v62, v63
    v_cvt_pk_bf16_f32 v62, v64, v65
    v_cvt_pk_bf16_f32 v63, v66, v67
    v_exp_f32 v68, v68
    v_exp_f32 v69, v69
    v_exp_f32 v70, v70
    v_mfma_f32_32x32x16_bf16 v[76:91], v[32:35], v[60:63], v[76:91]
    v_exp_f32 v71, v71
    v_exp_f32 v72, v72
    v_exp_f32 v73, v73
    v_exp_f32 v74, v74
    v_exp_f32 v75, v75
    v_cvt_pk_bf16_f32 v68, v68, v69
    v_cvt_pk_bf16_f32 v69, v70, v71
    v_cvt_pk_bf16_f32 v70, v72, v73
    v_cvt_pk_bf16_f32 v71, v74, v75
    v_exp_f32 v44, v44
    v_exp_f32 v45, v45
    v_mfma_f32_32x32x16_bf16 v[76:91], v[36:39], v[68:71], v[76:91]
    s_mov_b64 exec, s[36:37]
    ds_read_b128 v[32:35], v6 offset:27648
    ds_read_b128 v[36:39], v6 offset:28160
    s_mov_b64 exec, -1
    v_exp_f32 v46, v46
    v_exp_f32 v47, v47
    v_exp_f32 v48, v48
    v_exp_f32 v49, v49
    v_exp_f32 v50, v50
    s_waitcnt lgkmcnt(2)
    v_mfma_f32_32x32x16_bf16 v[60:75], v[20:23], v[12:15], v[92:107]
    ds_read_b128 v[16:19], v5 offset:28672
    v_exp_f32 v51, v51
    v_cvt_pk_bf16_f32 v44, v44, v45
    v_cvt_pk_bf16_f32 v45, v46, v47
    v_cvt_pk_bf16_f32 v46, v48, v49
    v_cvt_pk_bf16_f32 v47, v50, v51
    v_exp_f32 v52, v52
    v_exp_f32 v53, v53
    v_exp_f32 v54, v54
    v_mfma_f32_32x32x16_bf16 v[76:91], v[24:27], v[44:47], v[76:91]
    v_exp_f32 v55, v55
    v_exp_f32 v56, v56
    v_exp_f32 v57, v57
    v_exp_f32 v58, v58
    v_exp_f32 v59, v59
    v_cvt_pk_bf16_f32 v52, v52, v53
    v_cvt_pk_bf16_f32 v53, v54, v55
    v_cvt_pk_bf16_f32 v54, v56, v57
    v_cvt_pk_bf16_f32 v55, v58, v59
    v_exp_f32 v60, v60
    v_exp_f32 v61, v61
    v_mfma_f32_32x32x16_bf16 v[76:91], v[28:31], v[52:55], v[76:91]
    s_mov_b64 exec, s[36:37]
    ds_read_b128 v[24:27], v6 offset:28672
    ds_read_b128 v[28:31], v6 offset:29184
    s_mov_b64 exec, -1
    v_exp_f32 v62, v62
    v_exp_f32 v63, v63
    v_exp_f32 v64, v64
    v_exp_f32 v65, v65
    v_exp_f32 v66, v66
    s_waitcnt lgkmcnt(2)
    v_mfma_f32_32x32x16_bf16 v[44:59], v[16:19], v[12:15], v[92:107]
    s_cmp_lg_u32 s24, 0
    s_cbranch_scc1 f_f0c1
    s_mov_b32 s41, 18226176
    buffer_load_dwordx4 v[124:127], v4, s[20:23], s41 offen sc1
f_f0c1:
    ds_read_b128 v[20:23], v5 offset:29696
    v_exp_f32 v67, v67
    v_cvt_pk_bf16_f32 v60, v60, v61
    v_cvt_pk_bf16_f32 v61, v62, v63
    v_cvt_pk_bf16_f32 v62, v64, v65
    v_cvt_pk_bf16_f32 v63, v66, v67
    v_exp_f32 v68, v68
    v_exp_f32 v69, v69
    v_exp_f32 v70, v70
    v_mfma_f32_32x32x16_bf16 v[76:91], v[32:35], v[60:63], v[76:91]
    v_exp_f32 v71, v71
    v_exp_f32 v72, v72
    v_exp_f32 v73, v73
    v_exp_f32 v74, v74
    v_exp_f32 v75, v75
    v_cvt_pk_bf16_f32 v68, v68, v69
    v_cvt_pk_bf16_f32 v69, v70, v71
    v_cvt_pk_bf16_f32 v70, v72, v73
    v_cvt_pk_bf16_f32 v71, v74, v75
    v_exp_f32 v44, v44
    v_exp_f32 v45, v45
    v_mfma_f32_32x32x16_bf16 v[76:91], v[36:39], v[68:71], v[76:91]
    s_mov_b64 exec, s[36:37]
    ds_read_b128 v[32:35], v6 offset:29696
    ds_read_b128 v[36:39], v6 offset:30208
    s_mov_b64 exec, -1
    v_exp_f32 v46, v46
    v_exp_f32 v47, v47
    v_exp_f32 v48, v48
    v_exp_f32 v49, v49
    v_exp_f32 v50, v50
    s_waitcnt lgkmcnt(2)
    v_mfma_f32_32x32x16_bf16 v[60:75], v[20:23], v[12:15], v[92:107]
    ds_read_b128 v[16:19], v5 offset:30720
    v_exp_f32 v51, v51
    v_cvt_pk_bf16_f32 v44, v44, v45
    v_cvt_pk_bf16_f32 v45, v46, v47
    v_cvt_pk_bf16_f32 v46, v48, v49
    v_cvt_pk_bf16_f32 v47, v50, v51
    v_exp_f32 v52, v52
    v_exp_f32 v53, v53
    v_exp_f32 v54, v54
    v_mfma_f32_32x32x16_bf16 v[76:91], v[24:27], v[44:47], v[76:91]
    v_exp_f32 v55, v55
    v_exp_f32 v56, v56
    v_exp_f32 v57, v57
    v_exp_f32 v58, v58
    v_exp_f32 v59, v59
    v_cvt_pk_bf16_f32 v52, v52, v53
    v_cvt_pk_bf16_f32 v53, v54, v55
    v_cvt_pk_bf16_f32 v54, v56, v57
    v_cvt_pk_bf16_f32 v55, v58, v59
    v_exp_f32 v60, v60
    v_exp_f32 v61, v61
    v_mfma_f32_32x32x16_bf16 v[76:91], v[28:31], v[52:55], v[76:91]
    s_mov_b64 exec, s[36:37]
    ds_read_b128 v[24:27], v6 offset:30720
    ds_read_b128 v[28:31], v6 offset:31232
    s_mov_b64 exec, -1
    v_exp_f32 v62, v62
    v_exp_f32 v63, v63
    v_exp_f32 v64, v64
    v_exp_f32 v65, v65
    v_exp_f32 v66, v66
    s_waitcnt lgkmcnt(2)
    v_mfma_f32_32x32x16_bf16 v[44:59], v[16:19], v[12:15], v[92:107]
    ds_read_b128 v[20:23], v5 offset:31744
    v_exp_f32 v67, v67
    v_cvt_pk_bf16_f32 v60, v60, v61
    v_cvt_pk_bf16_f32 v61, v62, v63
    v_cvt_pk_bf16_f32 v62, v64, v65
    v_cvt_pk_bf16_f32 v63, v66, v67
    v_exp_f32 v68, v68
    v_exp_f32 v69, v69
    v_exp_f32 v70, v70
    v_mfma_f32_32x32x16_bf16 v[76:91], v[32:35], v[60:63], v[76:91]
    v_exp_f32 v71, v71
    v_exp_f32 v72, v72
    v_exp_f32 v73, v73
    v_exp_f32 v74, v74
    v_exp_f32 v75, v75
    v_cvt_pk_bf16_f32 v68, v68, v69
    v_cvt_pk_bf16_f32 v69, v70, v71
    v_cvt_pk_bf16_f32 v70, v72, v73
    v_cvt_pk_bf16_f32 v71, v74, v75
    v_exp_f32 v44, v44
    v_exp_f32 v45, v45
    v_mfma_f32_32x32x16_bf16 v[76:91], v[36:39], v[68:71], v[76:91]
    s_mov_b64 exec, s[36:37]
    ds_read_b128 v[32:35], v6 offset:31744
    ds_read_b128 v[36:39], v6 offset:32256
    s_mov_b64 exec, -1
    v_exp_f32 v46, v46
    v_exp_f32 v47, v47
    v_exp_f32 v48, v48
    v_exp_f32 v49, v49
    v_exp_f32 v50, v50
    s_waitcnt lgkmcnt(2)
    v_mfma_f32_32x32x16_bf16 v[60:75], v[20:23], v[12:15], v[92:107]
    s_waitcnt vmcnt(8)
    s_cmp_lg_u32 s24, 0
    s_cbranch_scc1 f_f0b2
    s_mov_b32 s41, 18226176
    s_mov_b32 s3, 0
    s_branch f_f0q2
f_f0p2:
    buffer_load_dwordx4 v[124:127], v4, s[20:23], s41 offen sc1
f_f0q2:
    s_add_u32 s3, s3, 1
    s_waitcnt vmcnt(0)
    v_and_b32 v2, v124, v125
    v_and_b32 v3, v126, v127
    v_and_b32 v2, v2, v3
    v_cmp_ne_u32 vcc, 1, v2
    s_cmp_gt_u32 s3, 0x40000
    s_cbranch_scc1 f_f0b2
    s_cbranch_vccnz f_f0p2
f_f0b2:
    s_barrier
    ds_read_b128 v[16:19], v5 offset:32768
    v_exp_f32 v51, v51
    v_cvt_pk_bf16_f32 v44, v44, v45
    v_cvt_pk_bf16_f32 v45, v46, v47
    v_cvt_pk_bf16_f32 v46, v48, v49
    v_cvt_pk_bf16_f32 v47, v50, v51
    v_exp_f32 v52, v52
    v_exp_f32 v53, v53
    v_exp_f32 v54, v54
    v_mfma_f32_32x32x16_bf16 v[76:91], v[24:27], v[44:47], v[76:91]
    v_exp_f32 v55, v55
    v_exp_f32 v56, v56
    v_exp_f32 v57, v57
    v_exp_f32 v58, v58
    v_exp_f32 v59, v59
    v_cvt_pk_bf16_f32 v52, v52, v53
    v_cvt_pk_bf16_f32 v53, v54, v55
    v_cvt_pk_bf16_f32 v54, v56, v57
    v_cvt_pk_bf16_f32 v55, v58, v59
    v_exp_f32 v60, v60
    v_exp_f32 v61, v61
    v_mfma_f32_32x32x16_bf16 v[76:91], v[28:31], v[52:55], v[76:91]
    s_mov_b64 exec, s[36:37]
    ds_read_b128 v[24:27], v6 offset:32768
    ds_read_b128 v[28:31], v6 offset:33280
    s_mov_b64 exec, -1
    v_exp_f32 v62, v62
    v_exp_f32 v63, v63
    v_exp_f32 v64, v64
    v_exp_f32 v65, v65
    v_exp_f32 v66, v66
    s_waitcnt lgkmcnt(2)
    v_mfma_f32_32x32x16_bf16 v[44:59], v[16:19], v[12:15], v[92:107]
    ds_read_b128 v[20:23], v5 offset:33792
    s_add_u32 s41, s30, 0
    buffer_load_dwordx4 a[0:3], v4, s[20:23], s41 offen offset:0 sc1
    buffer_load_dwordx4 a[4:7], v4, s[20:23], s41 offen offset:1024 sc1
    v_exp_f32 v67, v67
    v_cvt_pk_bf16_f32 v60, v60, v61
    v_cvt_pk_bf16_f32 v61, v62, v63
    v_cvt_pk_bf16_f32 v62, v64, v65
    v_cvt_pk_bf16_f32 v63, v66, v67
    v_exp_f32 v68, v68
    v_exp_f32 v69, v69
    v_exp_f32 v70, v70
    v_mfma_f32_32x32x16_bf16 v[76:91], v[32:35], v[60:63], v[76:91]
    v_exp_f32 v71, v71
    v_exp_f32 v72, v72
    v_exp_f32 v73, v73
    v_exp_f32 v74, v74
    v_exp_f32 v75, v75
    v_cvt_pk_bf16_f32 v68, v68, v69
    v_cvt_pk_bf16_f32 v69, v70, v71
    v_cvt_pk_bf16_f32 v70, v72, v73
    v_cvt_pk_bf16_f32 v71, v74, v75
    v_exp_f32 v44, v44
    v_exp_f32 v45, v45
    v_mfma_f32_32x32x16_bf16 v[76:91], v[36:39], v[68:71], v[76:91]
    s_mov_b64 exec, s[36:37]
    ds_read_b128 v[32:35], v6 offset:33792
    ds_read_b128 v[36:39], v6 offset:34304
    s_mov_b64 exec, -1
    v_exp_f32 v46, v46
    v_exp_f32 v47, v47
    v_exp_f32 v48, v48
    v_exp_f32 v49, v49
    v_exp_f32 v50, v50
    s_waitcnt lgkmcnt(2)
    v_mfma_f32_32x32x16_bf16 v[60:75], v[20:23], v[12:15], v[92:107]
    ds_read_b128 v[16:19], v5 offset:34816
    s_add_u32 m0, s39, 57344
    s_add_u32 s41, s40, 57344
    buffer_load_dwordx4 v4, s[20:23], s41 offen lds
    s_add_u32 m0, s39, 122880
    s_add_u32 s41, s40, 2154496
    buffer_load_dwordx4 v4, s[20:23], s41 offen lds
    s_add_u32 s41, s30, 2048
    buffer_load_dwordx4 a[8:11], v4, s[20:23], s41 offen offset:0 sc1
    buffer_load_dwordx4 a[12:15], v4, s[20:23], s41 offen offset:1024 sc1
    v_exp_f32 v51, v51
    v_cvt_pk_bf16_f32 v44, v44, v45
    v_cvt_pk_bf16_f32 v45, v46, v47
    v_cvt_pk_bf16_f32 v46, v48, v49
    v_cvt_pk_bf16_f32 v47, v50, v51
    v_exp_f32 v52, v52
    v_exp_f32 v53, v53
    v_exp_f32 v54, v54
    v_mfma_f32_32x32x16_bf16 v[76:91], v[24:27], v[44:47], v[76:91]
    v_exp_f32 v55, v55
    v_exp_f32 v56, v56
    v_exp_f32 v57, v57
    v_exp_f32 v58, v58
    v_exp_f32 v59, v59
    v_cvt_pk_bf16_f32 v52, v52, v53
    v_cvt_pk_bf16_f32 v53, v54, v55
    v_cvt_pk_bf16_f32 v54, v56, v57
    v_cvt_pk_bf16_f32 v55, v58, v59
    v_exp_f32 v60, v60
    v_exp_f32 v61, v61
    v_mfma_f32_32x32x16_bf16 v[76:91], v[28:31], v[52:55], v[76:91]
    s_mov_b64 exec, s[36:37]
    ds_read_b128 v[24:27], v6 offset:34816
    ds_read_b128 v[28:31], v6 offset:35328
    s_mov_b64 exec, -1
    v_exp_f32 v62, v62
    v_exp_f32 v63, v63
    v_exp_f32 v64, v64
    v_exp_f32 v65, v65
    v_exp_f32 v66, v66
    s_waitcnt lgkmcnt(2)
    v_mfma_f32_32x32x16_bf16 v[44:59], v[16:19], v[12:15], v[92:107]
    ds_read_b128 v[20:23], v5 offset:35840
    v_exp_f32 v67, v67
    v_cvt_pk_bf16_f32 v60, v60, v61
    v_cvt_pk_bf16_f32 v61, v62, v63
    v_cvt_pk_bf16_f32 v62, v64, v65
    v_cvt_pk_bf16_f32 v63, v66, v67
    v_exp_f32 v68, v68
    v_exp_f32 v69, v69
    v_exp_f32 v70, v70
    v_mfma_f32_32x32x16_bf16 v[76:91], v[32:35], v[60:63], v[76:91]
    v_exp_f32 v71, v71
    v_exp_f32 v72, v72
    v_exp_f32 v73, v73
    v_exp_f32 v74, v74
    v_exp_f32 v75, v75
    v_cvt_pk_bf16_f32 v68, v68, v69
    v_cvt_pk_bf16_f32 v69, v70, v71
    v_cvt_pk_bf16_f32 v70, v72, v73
    v_cvt_pk_bf16_f32 v71, v74, v75
    v_exp_f32 v44, v44
    v_exp_f32 v45, v45
    v_mfma_f32_32x32x16_bf16 v[76:91], v[36:39], v[68:71], v[76:91]
    s_mov_b64 exec, s[36:37]
    ds_read_b128 v[32:35], v6 offset:35840
    ds_read_b128 v[36:39], v6 offset:36352
    s_mov_b64 exec, -1
    v_exp_f32 v46, v46
    v_exp_f32 v47, v47
    v_exp_f32 v48, v48
    v_exp_f32 v49, v49
    v_exp_f32 v50, v50
    s_waitcnt lgkmcnt(2)
    v_mfma_f32_32x32x16_bf16 v[60:75], v[20:23], v[12:15], v[92:107]
    ds_read_b128 v[16:19], v5 offset:36864
    s_add_u32 s41, s30, 4096
    buffer_load_dwordx4 a[16:19], v4, s[20:23], s41 offen offset:0 sc1
    buffer_load_dwordx4 a[20:23], v4, s[20:23], s41 offen offset:1024 sc1
    v_exp_f32 v51, v51
    v_cvt_pk_bf16_f32 v44, v44, v45
    v_cvt_pk_bf16_f32 v45, v46, v47
    v_cvt_pk_bf16_f32 v46, v48, v49
    v_cvt_pk_bf16_f32 v47, v50, v51
    v_exp_f32 v52, v52
    v_exp_f32 v53, v53
    v_exp_f32 v54, v54
    v_mfma_f32_32x32x16_bf16 v[76:91], v[24:27], v[44:47], v[76:91]
    v_exp_f32 v55, v55
    v_exp_f32 v56, v56
    v_exp_f32 v57, v57
    v_exp_f32 v58, v58
    v_exp_f32 v59, v59
    v_cvt_pk_bf16_f32 v52, v52, v53
    v_cvt_pk_bf16_f32 v53, v54, v55
    v_cvt_pk_bf16_f32 v54, v56, v57
    v_cvt_pk_bf16_f32 v55, v58, v59
    v_exp_f32 v60, v60
    v_exp_f32 v61, v61
    v_mfma_f32_32x32x16_bf16 v[76:91], v[28:31], v[52:55], v[76:91]
    s_mov_b64 exec, s[36:37]
    ds_read_b128 v[24:27], v6 offset:36864
    ds_read_b128 v[28:31], v6 offset:37376
    s_mov_b64 exec, -1
    v_exp_f32 v62, v62
    v_exp_f32 v63, v63
    v_exp_f32 v64, v64
    v_exp_f32 v65, v65
    v_exp_f32 v66, v66
    s_waitcnt lgkmcnt(2)
    v_mfma_f32_32x32x16_bf16 v[44:59], v[16:19], v[12:15], v[92:107]
    ds_read_b128 v[20:23], v5 offset:37888
    s_add_u32 s41, s30, 6144
    buffer_load_dwordx4 a[24:27], v4, s[20:23], s41 offen offset:0 sc1
    buffer_load_dwordx4 a[28:31], v4, s[20:23], s41 offen offset:1024 sc1
    v_exp_f32 v67, v67
    v_cvt_pk_bf16_f32 v60, v60, v61
    v_cvt_pk_bf16_f32 v61, v62, v63
    v_cvt_pk_bf16_f32 v62, v64, v65
    v_cvt_pk_bf16_f32 v63, v66, v67
    v_exp_f32 v68, v68
    v_exp_f32 v69, v69
    v_exp_f32 v70, v70
    v_mfma_f32_32x32x16_bf16 v[76:91], v[32:35], v[60:63], v[76:91]
    v_exp_f32 v71, v71
    v_exp_f32 v72, v72
    v_exp_f32 v73, v73
    v_exp_f32 v74, v74
    v_exp_f32 v75, v75
    v_cvt_pk_bf16_f32 v68, v68, v69
    v_cvt_pk_bf16_f32 v69, v70, v71
    v_cvt_pk_bf16_f32 v70, v72, v73
    v_cvt_pk_bf16_f32 v71, v74, v75
    v_exp_f32 v44, v44
    v_exp_f32 v45, v45
    v_mfma_f32_32x32x16_bf16 v[76:91], v[36:39], v[68:71], v[76:91]
    s_mov_b64 exec, s[36:37]
    ds_read_b128 v[32:35], v6 offset:37888
    ds_read_b128 v[36:39], v6 offset:38400
    s_mov_b64 exec, -1
    v_exp_f32 v46, v46
    v_exp_f32 v47, v47
    v_exp_f32 v48, v48
    v_exp_f32 v49, v49
    v_exp_f32 v50, v50
    s_waitcnt lgkmcnt(2)
    v_mfma_f32_32x32x16_bf16 v[60:75], v[20:23], v[12:15], v[92:107]
    ds_read_b128 v[16:19], v5 offset:38912
    v_exp_f32 v51, v51
    v_cvt_pk_bf16_f32 v44, v44, v45
    v_cvt_pk_bf16_f32 v45, v46, v47
    v_cvt_pk_bf16_f32 v46, v48, v49
    v_cvt_pk_bf16_f32 v47, v50, v51
    v_exp_f32 v52, v52
    v_exp_f32 v53, v53
    v_exp_f32 v54, v54
    v_mfma_f32_32x32x16_bf16 v[76:91], v[24:27], v[44:47], v[76:91]
    v_exp_f32 v55, v55
    v_exp_f32 v56, v56
    v_exp_f32 v57, v57
    v_exp_f32 v58, v58
    v_exp_f32 v59, v59
    v_cvt_pk_bf16_f32 v52, v52, v53
    v_cvt_pk_bf16_f32 v53, v54, v55
    v_cvt_pk_bf16_f32 v54, v56, v57
    v_cvt_pk_bf16_f32 v55, v58, v59
    v_exp_f32 v60, v60
    v_exp_f32 v61, v61
    v_mfma_f32_32x32x16_bf16 v[76:91], v[28:31], v[52:55], v[76:91]
    s_mov_b64 exec, s[36:37]
    ds_read_b128 v[24:27], v6 offset:38912
    ds_read_b128 v[28:31], v6 offset:39424
    s_mov_b64 exec, -1
    v_exp_f32 v62, v62
    v_exp_f32 v63, v63
    v_exp_f32 v64, v64
    v_exp_f32 v65, v65
    v_exp_f32 v66, v66
    s_waitcnt lgkmcnt(2)
    v_mfma_f32_32x32x16_bf16 v[44:59], v[16:19], v[12:15], v[92:107]
    ds_read_b128 v[20:23], v5 offset:39936
    s_add_u32 s41, s30, 8192
    buffer_load_dwordx4 a[32:35], v4, s[20:23], s41 offen offset:0 sc1
    buffer_load_dwordx4 a[36:39], v4, s[20:23], s41 offen offset:1024 sc1
    v_exp_f32 v67, v67
    v_cvt_pk_bf16_f32 v60, v60, v61
    v_cvt_pk_bf16_f32 v61, v62, v63
    v_cvt_pk_bf16_f32 v62, v64, v65
    v_cvt_pk_bf16_f32 v63, v66, v67
    v_exp_f32 v68, v68
    v_exp_f32 v69, v69
    v_exp_f32 v70, v70
    v_mfma_f32_32x32x16_bf16 v[76:91], v[32:35], v[60:63], v[76:91]
    v_exp_f32 v71, v71
    v_exp_f32 v72, v72
    v_exp_f32 v73, v73
    v_exp_f32 v74, v74
    v_exp_f32 v75, v75
    v_cvt_pk_bf16_f32 v68, v68, v69
    v_cvt_pk_bf16_f32 v69, v70, v71
    v_cvt_pk_bf16_f32 v70, v72, v73
    v_cvt_pk_bf16_f32 v71, v74, v75
    v_exp_f32 v44, v44
    v_exp_f32 v45, v45
    v_mfma_f32_32x32x16_bf16 v[76:91], v[36:39], v[68:71], v[76:91]
    s_mov_b64 exec, s[36:37]
    ds_read_b128 v[32:35], v6 offset:39936
    ds_read_b128 v[36:39], v6 offset:40448
    s_mov_b64 exec, -1
    v_exp_f32 v46, v46
    v_exp_f32 v47, v47
    v_exp_f32 v48, v48
    v_exp_f32 v49, v49
    v_exp_f32 v50, v50
    s_waitcnt lgkmcnt(2)
    v_mfma_f32_32x32x16_bf16 v[60:75], v[20:23], v[12:15], v[92:107]
    s_waitcnt vmcnt(14)
    s_barrier
    ds_read_b128 v[16:19], v5 offset:40960
    s_add_u32 s41, s30, 10240
    buffer_load_dwordx4 a[40:43], v4, s[20:23], s41 offen offset:0 sc1
    buffer_load_dwordx4 a[44:47], v4, s[20:23], s41 offen offset:1024 sc1
    v_exp_f32 v51, v51
    v_cvt_pk_bf16_f32 v44, v44, v45
    v_cvt_pk_bf16_f32 v45, v46, v47
    v_cvt_pk_bf16_f32 v46, v48, v49
    v_cvt_pk_bf16_f32 v47, v50, v51
    v_exp_f32 v52, v52
    v_exp_f32 v53, v53
    v_exp_f32 v54, v54
    v_mfma_f32_32x32x16_bf16 v[76:91], v[24:27], v[44:47], v[76:91]
    v_exp_f32 v55, v55
    v_exp_f32 v56, v56
    v_exp_f32 v57, v57
    v_exp_f32 v58, v58
    v_exp_f32 v59, v59
    v_cvt_pk_bf16_f32 v52, v52, v53
    v_cvt_pk_bf16_f32 v53, v54, v55
    v_cvt_pk_bf16_f32 v54, v56, v57
    v_cvt_pk_bf16_f32 v55, v58, v59
    v_exp_f32 v60, v60
    v_exp_f32 v61, v61
    v_mfma_f32_32x32x16_bf16 v[76:91], v[28:31], v[52:55], v[76:91]
    s_mov_b64 exec, s[36:37]
    ds_read_b128 v[24:27], v6 offset:40960
    ds_read_b128 v[28:31], v6 offset:41472
    s_mov_b64 exec, -1
    v_exp_f32 v62, v62
    v_exp_f32 v63, v63
    v_exp_f32 v64, v64
    v_exp_f32 v65, v65
    v_exp_f32 v66, v66
    s_waitcnt lgkmcnt(2)
    v_mfma_f32_32x32x16_bf16 v[44:59], v[16:19], v[12:15], v[92:107]
    ds_read_b128 v[20:23], v5 offset:41984
    v_exp_f32 v67, v67
    v_cvt_pk_bf16_f32 v60, v60, v61
    v_cvt_pk_bf16_f32 v61, v62, v63
    v_cvt_pk_bf16_f32 v62, v64, v65
    v_cvt_pk_bf16_f32 v63, v66, v67
    v_exp_f32 v68, v68
    v_exp_f32 v69, v69
    v_exp_f32 v70, v70
    v_mfma_f32_32x32x16_bf16 v[76:91], v[32:35], v[60:63], v[76:91]
    v_exp_f32 v71, v71
    v_exp_f32 v72, v72
    v_exp_f32 v73, v73
    v_exp_f32 v74, v74
    v_exp_f32 v75, v75
    v_cvt_pk_bf16_f32 v68, v68, v69
    v_cvt_pk_bf16_f32 v69, v70, v71
    v_cvt_pk_bf16_f32 v70, v72, v73
    v_cvt_pk_bf16_f32 v71, v74, v75
    v_exp_f32 v44, v44
    v_exp_f32 v45, v45
    v_mfma_f32_32x32x16_bf16 v[76:91], v[36:39], v[68:71], v[76:91]
    s_mov_b64 exec, s[36:37]
    ds_read_b128 v[32:35], v6 offset:41984
    ds_read_b128 v[36:39], v6 offset:42496
    s_mov_b64 exec, -1
    v_exp_f32 v46, v46
    v_exp_f32 v47, v47
    v_exp_f32 v48, v48
    v_exp_f32 v49, v49
    v_exp_f32 v50, v50
    s_waitcnt lgkmcnt(2)
    v_mfma_f32_32x32x16_bf16 v[60:75], v[20:23], v[12:15], v[92:107]
    ds_read_b128 v[16:19], v5 offset:43008
    s_add_u32 s41, s30, 12288
    buffer_load_dwordx4 a[48:51], v4, s[20:23], s41 offen offset:0 sc1
    buffer_load_dwordx4 a[52:55], v4, s[20:23], s41 offen offset:1024 sc1
    s_waitcnt vmcnt(14)
    v_mfma_f32_32x32x16_bf16 v[108:123], a[0:3], v[40:43], v[108:123]
    v_mfma_f32_32x32x16_bf16 v[108:123], a[4:7], v[40:43], v[108:123]
    v_exp_f32 v51, v51
    v_cvt_pk_bf16_f32 v44, v44, v45
    v_cvt_pk_bf16_f32 v45, v46, v47
    v_cvt_pk_bf16_f32 v46, v48, v49
    v_cvt_pk_bf16_f32 v47, v50, v51
    v_exp_f32 v52, v52
    v_exp_f32 v53, v53
    v_exp_f32 v54, v54
    v_mfma_f32_32x32x16_bf16 v[76:91], v[24:27], v[44:47], v[76:91]
    v_exp_f32 v55, v55
    v_exp_f32 v56, v56
    v_exp_f32 v57, v57
    v_exp_f32 v58, v58
    v_exp_f32 v59, v59
    v_cvt_pk_bf16_f32 v52, v52, v53
    v_cvt_pk_bf16_f32 v53, v54, v55
    v_cvt_pk_bf16_f32 v54, v56, v57
    v_cvt_pk_bf16_f32 v55, v58, v59
    v_exp_f32 v60, v60
    v_exp_f32 v61, v61
    v_mfma_f32_32x32x16_bf16 v[76:91], v[28:31], v[52:55], v[76:91]
    s_mov_b64 exec, s[36:37]
    ds_read_b128 v[24:27], v6 offset:43008
    ds_read_b128 v[28:31], v6 offset:43520
    s_mov_b64 exec, -1
    v_exp_f32 v62, v62
    v_exp_f32 v63, v63
    v_exp_f32 v64, v64
    v_exp_f32 v65, v65
    v_exp_f32 v66, v66
    s_waitcnt lgkmcnt(2)
    v_mfma_f32_32x32x16_bf16 v[44:59], v[16:19], v[12:15], v[92:107]
    ds_read_b128 v[20:23], v5 offset:44032
    s_add_u32 s41, s30, 14336
    buffer_load_dwordx4 a[56:59], v4, s[20:23], s41 offen offset:0 sc1
    buffer_load_dwordx4 a[60:63], v4, s[20:23], s41 offen offset:1024 sc1
    s_waitcnt vmcnt(12)
    v_mfma_f32_32x32x16_bf16 v[108:123], a[8:11], v[40:43], v[108:123]
    v_mfma_f32_32x32x16_bf16 v[108:123], a[12:15], v[40:43], v[108:123]
    s_add_u32 m0, s33, 0
    s_add_u32 s41, s32, 0
    buffer_load_dwordx4 v9, s[44:47], s41 offen lds
    v_exp_f32 v67, v67
    v_cvt_pk_bf16_f32 v60, v60, v61
    v_cvt_pk_bf16_f32 v61, v62, v63
    v_cvt_pk_bf16_f32 v62, v64, v65
    v_cvt_pk_bf16_f32 v63, v66, v67
    v_exp_f32 v68, v68
    v_exp_f32 v69, v69
    v_exp_f32 v70, v70
    v_mfma_f32_32x32x16_bf16 v[76:91], v[32:35], v[60:63], v[76:91]
    v_exp_f32 v71, v71
    v_exp_f32 v72, v72
    v_exp_f32 v73, v73
    v_exp_f32 v74, v74
    v_exp_f32 v75, v75
    v_cvt_pk_bf16_f32 v68, v68, v69
    v_cvt_pk_bf16_f32 v69, v70, v71
    v_cvt_pk_bf16_f32 v70, v72, v73
    v_cvt_pk_bf16_f32 v71, v74, v75
    v_exp_f32 v44, v44
    v_exp_f32 v45, v45
    v_mfma_f32_32x32x16_bf16 v[76:91], v[36:39], v[68:71], v[76:91]
    s_mov_b64 exec, s[36:37]
    ds_read_b128 v[32:35], v6 offset:44032
    ds_read_b128 v[36:39], v6 offset:44544
    s_mov_b64 exec, -1
    v_exp_f32 v46, v46
    v_exp_f32 v47, v47
    v_exp_f32 v48, v48
    v_exp_f32 v49, v49
    v_exp_f32 v50, v50
    s_waitcnt lgkmcnt(2)
    v_mfma_f32_32x32x16_bf16 v[60:75], v[20:23], v[12:15], v[92:107]
    ds_read_b128 v[16:19], v5 offset:45056
    s_add_u32 m0, s33, 1024
    s_add_u32 s41, s32, 8192
    buffer_load_dwordx4 v9, s[44:47], s41 offen lds
    v_exp_f32 v51, v51
    v_cvt_pk_bf16_f32 v44, v44, v45
    v_cvt_pk_bf16_f32 v45, v46, v47
    v_cvt_pk_bf16_f32 v46, v48, v49
    v_cvt_pk_bf16_f32 v47, v50, v51
    v_exp_f32 v52, v52
    v_exp_f32 v53, v53
    v_exp_f32 v54, v54
    v_mfma_f32_32x32x16_bf16 v[76:91], v[24:27], v[44:47], v[76:91]
    v_exp_f32 v55, v55
    v_exp_f32 v56, v56
    v_exp_f32 v57, v57
    v_exp_f32 v58, v58
    v_exp_f32 v59, v59
    v_cvt_pk_bf16_f32 v52, v52, v53
    v_cvt_pk_bf16_f32 v53, v54, v55
    v_cvt_pk_bf16_f32 v54, v56, v57
    v_cvt_pk_bf16_f32 v55, v58, v59
    v_exp_f32 v60, v60
    v_exp_f32 v61, v61
    v_mfma_f32_32x32x16_bf16 v[76:91], v[28:31], v[52:55], v[76:91]
    s_mov_b64 exec, s[36:37]
    ds_read_b128 v[24:27], v6 offset:45056
    ds_read_b128 v[28:31], v6 offset:45568
    s_mov_b64 exec, -1
    v_exp_f32 v62, v62
    v_exp_f32 v63, v63
    v_exp_f32 v64, v64
    v_exp_f32 v65, v65
    v_exp_f32 v66, v66
    s_waitcnt lgkmcnt(2)
    v_mfma_f32_32x32x16_bf16 v[44:59], v[16:19], v[12:15], v[92:107]
    ds_read_b128 v[20:23], v5 offset:46080
    s_add_u32 s41, s30, 16384
    buffer_load_dwordx4 a[64:67], v4, s[20:23], s41 offen offset:0 sc1
    buffer_load_dwordx4 a[68:71], v4, s[20:23], s41 offen offset:1024 sc1
    s_waitcnt vmcnt(14)
    v_mfma_f32_32x32x16_bf16 v[108:123], a[16:19], v[40:43], v[108:123]
    v_mfma_f32_32x32x16_bf16 v[108:123], a[20:23], v[40:43], v[108:123]
    v_exp_f32 v67, v67
    v_cvt_pk_bf16_f32 v60, v60, v61
    v_cvt_pk_bf16_f32 v61, v62, v63
    v_cvt_pk_bf16_f32 v62, v64, v65
    v_cvt_pk_bf16_f32 v63, v66, v67
    v_exp_f32 v68, v68
    v_exp_f32 v69, v69
    v_exp_f32 v70, v70
    v_mfma_f32_32x32x16_bf16 v[76:91], v[32:35], v[60:63], v[76:91]
    v_exp_f32 v71, v71
    v_exp_f32 v72, v72
    v_exp_f32 v73, v73
    v_exp_f32 v74, v74
    v_exp_f32 v75, v75
    v_cvt_pk_bf16_f32 v68, v68, v69
    v_cvt_pk_bf16_f32 v69, v70, v71
    v_cvt_pk_bf16_f32 v70, v72, v73
    v_cvt_pk_bf16_f32 v71, v74, v75
    v_exp_f32 v44, v44
    v_exp_f32 v45, v45
    v_mfma_f32_32x32x16_bf16 v[76:91], v[36:39], v[68:71], v[76:91]
    s_mov_b64 exec, s[36:37]
    ds_read_b128 v[32:35], v6 offset:46080
    ds_read_b128 v[36:39], v6 offset:46592
    s_mov_b64 exec, -1
    v_exp_f32 v46, v46
    v_exp_f32 v47, v47
    v_exp_f32 v48, v48
    v_exp_f32 v49, v49
    v_exp_f32 v50, v50
    s_waitcnt lgkmcnt(2)
    v_mfma_f32_32x32x16_bf16 v[60:75], v[20:23], v[12:15], v[92:107]
    ds_read_b128 v[16:19], v5 offset:47104
    s_add_u32 s41, s30, 18432
    buffer_load_dwordx4 a[72:75], v4, s[20:23], s41 offen offset:0 sc1
    buffer_load_dwordx4 a[76:79], v4, s[20:23], s41 offen offset:1024 sc1
    s_waitcnt vmcnt(14)
    v_mfma_f32_32x32x16_bf16 v[108:123], a[24:27], v[40:43], v[108:123]
    v_mfma_f32_32x32x16_bf16 v[108:123], a[28:31], v[40:43], v[108:123]
    v_exp_f32 v51, v51
    v_cvt_pk_bf16_f32 v44, v44, v45
    v_cvt_pk_bf16_f32 v45, v46, v47
    v_cvt_pk_bf16_f32 v46, v48, v49
    v_cvt_pk_bf16_f32 v47, v50, v51
    v_exp_f32 v52, v52
    v_exp_f32 v53, v53
    v_exp_f32 v54, v54
    v_mfma_f32_32x32x16_bf16 v[76:91], v[24:27], v[44:47], v[76:91]
    v_exp_f32 v55, v55
    v_exp_f32 v56, v56
    v_exp_f32 v57, v57
    v_exp_f32 v58, v58
    v_exp_f32 v59, v59
    v_cvt_pk_bf16_f32 v52, v52, v53
    v_cvt_pk_bf16_f32 v53, v54, v55
    v_cvt_pk_bf16_f32 v54, v56, v57
    v_cvt_pk_bf16_f32 v55, v58, v59
    v_exp_f32 v60, v60
    v_exp_f32 v61, v61
    v_mfma_f32_32x32x16_bf16 v[76:91], v[28:31], v[52:55], v[76:91]
    s_mov_b64 exec, s[36:37]
    ds_read_b128 v[24:27], v6 offset:47104
    ds_read_b128 v[28:31], v6 offset:47616
    s_mov_b64 exec, -1
    v_exp_f32 v62, v62
    v_exp_f32 v63, v63
    v_exp_f32 v64, v64
    v_exp_f32 v65, v65
    v_exp_f32 v66, v66
    s_waitcnt lgkmcnt(2)
    v_mfma_f32_32x32x16_bf16 v[44:59], v[16:19], v[12:15], v[92:107]
    ds_read_b128 v[20:23], v5 offset:48128
    s_add_u32 m0, s33, 2048
    s_add_u32 s41, s32, 16384
    buffer_load_dwordx4 v9, s[44:47], s41 offen lds
    v_exp_f32 v67, v67
    v_cvt_pk_bf16_f32 v60, v60, v61
    v_cvt_pk_bf16_f32 v61, v62, v63
    v_cvt_pk_bf16_f32 v62, v64, v65
    v_cvt_pk_bf16_f32 v63, v66, v67
    v_exp_f32 v68, v68
    v_exp_f32 v69, v69
    v_exp_f32 v70, v70
    v_mfma_f32_32x32x16_bf16 v[76:91], v[32:35], v[60:63], v[76:91]
    v_exp_f32 v71, v71
    v_exp_f32 v72, v72
    v_exp_f32 v73, v73
    v_exp_f32 v74, v74
    v_exp_f32 v75, v75
    v_cvt_pk_bf16_f32 v68, v68, v69
    v_cvt_pk_bf16_f32 v69, v70, v71
    v_cvt_pk_bf16_f32 v70, v72, v73
    v_cvt_pk_bf16_f32 v71, v74, v75
    v_exp_f32 v44, v44
    v_exp_f32 v45, v45
    v_mfma_f32_32x32x16_bf16 v[76:91], v[36:39], v[68:71], v[76:91]
    s_mov_b64 exec, s[36:37]
    ds_read_b128 v[32:35], v6 offset:48128
    ds_read_b128 v[36:39], v6 offset:48640
    s_mov_b64 exec, -1
    v_exp_f32 v46, v46
    v_exp_f32 v47, v47
    v_exp_f32 v48, v48
    v_exp_f32 v49, v49
    v_exp_f32 v50, v50
    s_waitcnt lgkmcnt(2)
    v_mfma_f32_32x32x16_bf16 v[60:75], v[20:23], v[12:15], v[92:107]
    s_waitcnt vmcnt(25)
    s_barrier
    ds_read_b128 v[16:19], v5 offset:49152
    s_add_u32 s41, s30, 20480
    buffer_load_dwordx4 a[80:83], v4, s[20:23], s41 offen offset:0 sc1
    buffer_load_dwordx4 a[84:87], v4, s[20:23], s41 offen offset:1024 sc1
    s_waitcnt vmcnt(15)
    v_mfma_f32_32x32x16_bf16 v[108:123], a[32:35], v[40:43], v[108:123]
    v_mfma_f32_32x32x16_bf16 v[108:123], a[36:39], v[40:43], v[108:123]
    s_add_u32 m0, s33, 3072
    s_add_u32 s41, s32, 24576
    buffer_load_dwordx4 v9, s[44:47], s41 offen lds
    v_exp_f32 v51, v51
    v_cvt_pk_bf16_f32 v44, v44, v45
    v_cvt_pk_bf16_f32 v45, v46, v47
    v_cvt_pk_bf16_f32 v46, v48, v49
    v_cvt_pk_bf16_f32 v47, v50, v51
    v_exp_f32 v52, v52
    v_exp_f32 v53, v53
    v_exp_f32 v54, v54
    v_mfma_f32_32x32x16_bf16 v[76:91], v[24:27], v[44:47], v[76:91]
    v_exp_f32 v55, v55
    v_exp_f32 v56, v56
    v_exp_f32 v57, v57
    v_exp_f32 v58, v58
    v_exp_f32 v59, v59
    v_cvt_pk_bf16_f32 v52, v52, v53
    v_cvt_pk_bf16_f32 v53, v54, v55
    v_cvt_pk_bf16_f32 v54, v56, v57
    v_cvt_pk_bf16_f32 v55, v58, v59
    v_exp_f32 v60, v60
    v_exp_f32 v61, v61
    v_mfma_f32_32x32x16_bf16 v[76:91], v[28:31], v[52:55], v[76:91]
    s_mov_b64 exec, s[36:37]
    ds_read_b128 v[24:27], v6 offset:49152
    ds_read_b128 v[28:31], v6 offset:49664
    s_mov_b64 exec, -1
    v_exp_f32 v62, v62
    v_exp_f32 v63, v63
    v_exp_f32 v64, v64
    v_exp_f32 v65, v65
    v_exp_f32 v66, v66
    s_waitcnt lgkmcnt(2)
    v_mfma_f32_32x32x16_bf16 v[44:59], v[16:19], v[12:15], v[92:107]
    ds_read_b128 v[20:23], v5 offset:50176
    s_add_u32 s41, s30, 22528
    buffer_load_dwordx4 a[88:91], v4, s[20:23], s41 offen offset:0 sc1
    buffer_load_dwordx4 a[92:95], v4, s[20:23], s41 offen offset:1024 sc1
    s_waitcnt vmcnt(16)
    v_mfma_f32_32x32x16_bf16 v[108:123], a[40:43], v[40:43], v[108:123]
    v_mfma_f32_32x32x16_bf16 v[108:123], a[44:47], v[40:43], v[108:123]
    v_exp_f32 v67, v67
    v_cvt_pk_bf16_f32 v60, v60, v61
    v_cvt_pk_bf16_f32 v61, v62, v63
    v_cvt_pk_bf16_f32 v62, v64, v65
    v_cvt_pk_bf16_f32 v63, v66, v67
    v_exp_f32 v68, v68
    v_exp_f32 v69, v69
    v_exp_f32 v70, v70
    v_mfma_f32_32x32x16_bf16 v[76:91], v[32:35], v[60:63], v[76:91]
    v_exp_f32 v71, v71
    v_exp_f32 v72, v72
    v_exp_f32 v73, v73
    v_exp_f32 v74, v74
    v_exp_f32 v75, v75
    v_cvt_pk_bf16_f32 v68, v68, v69
    v_cvt_pk_bf16_f32 v69, v70, v71
    v_cvt_pk_bf16_f32 v70, v72, v73
    v_cvt_pk_bf16_f32 v71, v74, v75
    v_exp_f32 v44, v44
    v_exp_f32 v45, v45
    v_mfma_f32_32x32x16_bf16 v[76:91], v[36:39], v[68:71], v[76:91]
    s_mov_b64 exec, s[36:37]
    ds_read_b128 v[32:35], v6 offset:50176
    ds_read_b128 v[36:39], v6 offset:50688
    s_mov_b64 exec, -1
    v_exp_f32 v46, v46
    v_exp_f32 v47, v47
    v_exp_f32 v48, v48
    v_exp_f32 v49, v49
    v_exp_f32 v50, v50
    s_waitcnt lgkmcnt(2)
    v_mfma_f32_32x32x16_bf16 v[60:75], v[20:23], v[12:15], v[92:107]
    ds_read_b128 v[16:19], v5 offset:51200
    v_exp_f32 v51, v51
    v_cvt_pk_bf16_f32 v44, v44, v45
    v_cvt_pk_bf16_f32 v45, v46, v47
    v_cvt_pk_bf16_f32 v46, v48, v49
    v_cvt_pk_bf16_f32 v47, v50, v51
    v_exp_f32 v52, v52
    v_exp_f32 v53, v53
    v_exp_f32 v54, v54
    v_mfma_f32_32x32x16_bf16 v[76:91], v[24:27], v[44:47], v[76:91]
    v_exp_f32 v55, v55
    v_exp_f32 v56, v56
    v_exp_f32 v57, v57
    v_exp_f32 v58, v58
    v_exp_f32 v59, v59
    v_cvt_pk_bf16_f32 v52, v52, v53
    v_cvt_pk_bf16_f32 v53, v54, v55
    v_cvt_pk_bf16_f32 v54, v56, v57
    v_cvt_pk_bf16_f32 v55, v58, v59
    v_exp_f32 v60, v60
    v_exp_f32 v61, v61
    v_mfma_f32_32x32x16_bf16 v[76:91], v[28:31], v[52:55], v[76:91]
    s_mov_b64 exec, s[36:37]
    ds_read_b128 v[24:27], v6 offset:51200
    ds_read_b128 v[28:31], v6 offset:51712
    s_mov_b64 exec, -1
    v_exp_f32 v62, v62
    v_exp_f32 v63, v63
    v_exp_f32 v64, v64
    v_exp_f32 v65, v65
    v_exp_f32 v66, v66
    s_waitcnt lgkmcnt(2)
    v_mfma_f32_32x32x16_bf16 v[44:59], v[16:19], v[12:15], v[92:107]
    ds_read_b128 v[20:23], v5 offset:52224
    s_add_u32 s41, s30, 24576
    buffer_load_dwordx4 a[96:99], v4, s[20:23], s41 offen offset:0 sc1
    buffer_load_dwordx4 a[100:103], v4, s[20:23], s41 offen offset:1024 sc1
    s_waitcnt vmcnt(16)
    v_mfma_f32_32x32x16_bf16 v[108:123], a[48:51], v[40:43], v[108:123]
    v_mfma_f32_32x32x16_bf16 v[108:123], a[52:55], v[40:43], v[108:123]
    s_add_u32 m0, s33, 4096
    s_add_u32 s41, s32, 32768
    buffer_load_dwordx4 v9, s[44:47], s41 offen lds
    v_exp_f32 v67, v67
    v_cvt_pk_bf16_f32 v60, v60, v61
    v_cvt_pk_bf16_f32 v61, v62, v63
    v_cvt_pk_bf16_f32 v62, v64, v65
    v_cvt_pk_bf16_f32 v63, v66, v67
    v_exp_f32 v68, v68
    v_exp_f32 v69, v69
    v_exp_f32 v70, v70
    v_mfma_f32_32x32x16_bf16 v[76:91], v[32:35], v[60:63], v[76:91]
    v_exp_f32 v71, v71
    v_exp_f32 v72, v72
    v_exp_f32 v73, v73
    v_exp_f32 v74, v74
    v_exp_f32 v75, v75
    v_cvt_pk_bf16_f32 v68, v68, v69
    v_cvt_pk_bf16_f32 v69, v70, v71
    v_cvt_pk_bf16_f32 v70, v72, v73
    v_cvt_pk_bf16_f32 v71, v74, v75
    v_exp_f32 v44, v44
    v_exp_f32 v45, v45
    v_mfma_f32_32x32x16_bf16 v[76:91], v[36:39], v[68:71], v[76:91]
    s_mov_b64 exec, s[36:37]
    ds_read_b128 v[32:35], v6 offset:52224
    ds_read_b128 v[36:39], v6 offset:52736
    s_mov_b64 exec, -1
    v_exp_f32 v46, v46
    v_exp_f32 v47, v47
    v_exp_f32 v48, v48
    v_exp_f32 v49, v49
    v_exp_f32 v50, v50
    s_waitcnt lgkmcnt(2)
    v_mfma_f32_32x32x16_bf16 v[60:75], v[20:23], v[12:15], v[92:107]
    ds_read_b128 v[16:19], v5 offset:53248
    s_add_u32 s41, s30, 26624
    buffer_load_dwordx4 a[104:107], v4, s[20:23], s41 offen offset:0 sc1
    buffer_load_dwordx4 a[108:111], v4, s[20:23], s41 offen offset:1024 sc1
    s_waitcnt vmcnt(17)
    v_mfma_f32_32x32x16_bf16 v[108:123], a[56:59], v[40:43], v[108:123]
    v_mfma_f32_32x32x16_bf16 v[108:123], a[60:63], v[40:43], v[108:123]
    s_add_u32 m0, s33, 5120
    s_add_u32 s41, s32, 40960
    buffer_load_dwordx4 v9, s[44:47], s41 offen lds
    v_exp_f32 v51, v51
    v_cvt_pk_bf16_f32 v44, v44, v45
    v_cvt_pk_bf16_f32 v45, v46, v47
    v_cvt_pk_bf16_f32 v46, v48, v49
    v_cvt_pk_bf16_f32 v47, v50, v51
    v_exp_f32 v52, v52
    v_exp_f32 v53, v53
    v_exp_f32 v54, v54
    v_mfma_f32_32x32x16_bf16 v[76:91], v[24:27], v[44:47], v[76:91]
    v_exp_f32 v55, v55
    v_exp_f32 v56, v56
    v_exp_f32 v57, v57
    v_exp_f32 v58, v58
    v_exp_f32 v59, v59
    v_cvt_pk_bf16_f32 v52, v52, v53
    v_cvt_pk_bf16_f32 v53, v54, v55
    v_cvt_pk_bf16_f32 v54, v56, v57
    v_cvt_pk_bf16_f32 v55, v58, v59
    v_exp_f32 v60, v60
    v_exp_f32 v61, v61
    v_mfma_f32_32x32x16_bf16 v[76:91], v[28:31], v[52:55], v[76:91]
    s_mov_b64 exec, s[36:37]
    ds_read_b128 v[24:27], v6 offset:53248
    ds_read_b128 v[28:31], v6 offset:53760
    s_mov_b64 exec, -1
    v_exp_f32 v62, v62
    v_exp_f32 v63, v63
    v_exp_f32 v64, v64
    v_exp_f32 v65, v65
    v_exp_f32 v66, v66
    s_waitcnt lgkmcnt(2)
    v_mfma_f32_32x32x16_bf16 v[44:59], v[16:19], v[12:15], v[92:107]
    ds_read_b128 v[20:23], v5 offset:54272
    v_exp_f32 v67, v67
    v_cvt_pk_bf16_f32 v60, v60, v61
    v_cvt_pk_bf16_f32 v61, v62, v63
    v_cvt_pk_bf16_f32 v62, v64, v65
    v_cvt_pk_bf16_f32 v63, v66, v67
    v_exp_f32 v68, v68
    v_exp_f32 v69, v69
    v_exp_f32 v70, v70
    v_mfma_f32_32x32x16_bf16 v[76:91], v[32:35], v[60:63], v[76:91]
    v_exp_f32 v71, v71
    v_exp_f32 v72, v72
    v_exp_f32 v73, v73
    v_exp_f32 v74, v74
    v_exp_f32 v75, v75
    v_cvt_pk_bf16_f32 v68, v68, v69
    v_cvt_pk_bf16_f32 v69, v70, v71
    v_cvt_pk_bf16_f32 v70, v72, v73
    v_cvt_pk_bf16_f32 v71, v74, v75
    v_exp_f32 v44, v44
    v_exp_f32 v45, v45
    v_mfma_f32_32x32x16_bf16 v[76:91], v[36:39], v[68:71], v[76:91]
    s_mov_b64 exec, s[36:37]
    ds_read_b128 v[32:35], v6 offset:54272
    ds_read_b128 v[36:39], v6 offset:54784
    s_mov_b64 exec, -1
    v_exp_f32 v46, v46
    v_exp_f32 v47, v47
    v_exp_f32 v48, v48
    v_exp_f32 v49, v49
    v_exp_f32 v50, v50
    s_waitcnt lgkmcnt(2)
    v_mfma_f32_32x32x16_bf16 v[60:75], v[20:23], v[12:15], v[92:107]
    ds_read_b128 v[16:19], v5 offset:55296
    s_add_u32 s41, s30, 28672
    buffer_load_dwordx4 a[112:115], v4, s[20:23], s41 offen offset:0 sc1
    buffer_load_dwordx4 a[116:119], v4, s[20:23], s41 offen offset:1024 sc1
    s_waitcnt vmcnt(16)
    v_mfma_f32_32x32x16_bf16 v[108:123], a[64:67], v[40:43], v[108:123]
    v_mfma_f32_32x32x16_bf16 v[108:123], a[68:71], v[40:43], v[108:123]
    v_exp_f32 v51, v51
    v_cvt_pk_bf16_f32 v44, v44, v45
    v_cvt_pk_bf16_f32 v45, v46, v47
    v_cvt_pk_bf16_f32 v46, v48, v49
    v_cvt_pk_bf16_f32 v47, v50, v51
    v_exp_f32 v52, v52
    v_exp_f32 v53, v53
    v_exp_f32 v54, v54
    v_mfma_f32_32x32x16_bf16 v[76:91], v[24:27], v[44:47], v[76:91]
    v_exp_f32 v55, v55
    v_exp_f32 v56, v56
    v_exp_f32 v57, v57
    v_exp_f32 v58, v58
    v_exp_f32 v59, v59
    v_cvt_pk_bf16_f32 v52, v52, v53
    v_cvt_pk_bf16_f32 v53, v54, v55
    v_cvt_pk_bf16_f32 v54, v56, v57
    v_cvt_pk_bf16_f32 v55, v58, v59
    v_exp_f32 v60, v60
    v_exp_f32 v61, v61
    v_mfma_f32_32x32x16_bf16 v[76:91], v[28:31], v[52:55], v[76:91]
    s_mov_b64 exec, s[36:37]
    ds_read_b128 v[24:27], v6 offset:55296
    ds_read_b128 v[28:31], v6 offset:55808
    s_mov_b64 exec, -1
    v_exp_f32 v62, v62
    v_exp_f32 v63, v63
    v_exp_f32 v64, v64
    v_exp_f32 v65, v65
    v_exp_f32 v66, v66
    s_waitcnt lgkmcnt(2)
    v_mfma_f32_32x32x16_bf16 v[44:59], v[16:19], v[12:15], v[92:107]
    ds_read_b128 v[20:23], v5 offset:56320
    s_waitcnt vmcnt(14)
    v_mfma_f32_32x32x16_bf16 v[108:123], a[72:75], v[40:43], v[108:123]
    v_mfma_f32_32x32x16_bf16 v[108:123], a[76:79], v[40:43], v[108:123]
    s_add_u32 m0, s33, 6144
    s_add_u32 s41, s32, 49152
    buffer_load_dwordx4 v9, s[44:47], s41 offen lds
    v_exp_f32 v67, v67
    v_cvt_pk_bf16_f32 v60, v60, v61
    v_cvt_pk_bf16_f32 v61, v62, v63
    v_cvt_pk_bf16_f32 v62, v64, v65
    v_cvt_pk_bf16_f32 v63, v66, v67
    v_exp_f32 v68, v68
    v_exp_f32 v69, v69
    v_exp_f32 v70, v70
    v_mfma_f32_32x32x16_bf16 v[76:91], v[32:35], v[60:63], v[76:91]
    v_exp_f32 v71, v71
    v_exp_f32 v72, v72
    v_exp_f32 v73, v73
    v_exp_f32 v74, v74
    v_exp_f32 v75, v75
    v_cvt_pk_bf16_f32 v68, v68, v69
    v_cvt_pk_bf16_f32 v69, v70, v71
    v_cvt_pk_bf16_f32 v70, v72, v73
    v_cvt_pk_bf16_f32 v71, v74, v75
    v_exp_f32 v44, v44
    v_exp_f32 v45, v45
    v_mfma_f32_32x32x16_bf16 v[76:91], v[36:39], v[68:71], v[76:91]
    s_mov_b64 exec, s[36:37]
    ds_read_b128 v[32:35], v6 offset:56320
    ds_read_b128 v[36:39], v6 offset:56832
    s_mov_b64 exec, -1
    v_exp_f32 v46, v46
    v_exp_f32 v47, v47
    v_exp_f32 v48, v48
    v_exp_f32 v49, v49
    v_exp_f32 v50, v50
    s_waitcnt lgkmcnt(2)
    v_mfma_f32_32x32x16_bf16 v[60:75], v[20:23], v[12:15], v[92:107]
    s_waitcnt vmcnt(35)
    s_barrier
    ds_read_b128 v[16:19], v5 offset:57344
    s_add_u32 s41, s30, 30720
    buffer_load_dwordx4 a[120:123], v4, s[20:23], s41 offen offset:0 sc1
    buffer_load_dwordx4 a[124:127], v4, s[20:23], s41 offen offset:1024 sc1
    s_add_u32 m0, s33, 7168
    s_add_u32 s41, s32, 57344
    buffer_load_dwordx4 v9, s[44:47], s41 offen lds
    v_exp_f32 v51, v51
    v_cvt_pk_bf16_f32 v44, v44, v45
    v_cvt_pk_bf16_f32 v45, v46, v47
    v_cvt_pk_bf16_f32 v46, v48, v49
    v_cvt_pk_bf16_f32 v47, v50, v51
    v_exp_f32 v52, v52
    v_exp_f32 v53, v53
    v_exp_f32 v54, v54
    v_mfma_f32_32x32x16_bf16 v[76:91], v[24:27], v[44:47], v[76:91]
    v_exp_f32 v55, v55
    v_exp_f32 v56, v56
    v_exp_f32 v57, v57
    v_exp_f32 v58, v58
    v_exp_f32 v59, v59
    v_cvt_pk_bf16_f32 v52, v52, v53
    v_cvt_pk_bf16_f32 v53, v54, v55
    v_cvt_pk_bf16_f32 v54, v56, v57
    v_cvt_pk_bf16_f32 v55, v58, v59
    v_exp_f32 v60, v60
    v_exp_f32 v61, v61
    v_mfma_f32_32x32x16_bf16 v[76:91], v[28:31], v[52:55], v[76:91]
    s_mov_b64 exec, s[36:37]
    ds_read_b128 v[24:27], v6 offset:57344
    ds_read_b128 v[28:31], v6 offset:57856
    s_mov_b64 exec, -1
    v_exp_f32 v62, v62
    v_exp_f32 v63, v63
    v_exp_f32 v64, v64
    v_exp_f32 v65, v65
    v_exp_f32 v66, v66
    s_waitcnt lgkmcnt(2)
    v_mfma_f32_32x32x16_bf16 v[44:59], v[16:19], v[12:15], v[92:107]
    ds_read_b128 v[20:23], v5 offset:58368
    s_waitcnt vmcnt(15)
    v_mfma_f32_32x32x16_bf16 v[108:123], a[80:83], v[40:43], v[108:123]
    v_mfma_f32_32x32x16_bf16 v[108:123], a[84:87], v[40:43], v[108:123]
    v_exp_f32 v67, v67
    v_cvt_pk_bf16_f32 v60, v60, v61
    v_cvt_pk_bf16_f32 v61, v62, v63
    v_cvt_pk_bf16_f32 v62, v64, v65
    v_cvt_pk_bf16_f32 v63, v66, v67
    v_exp_f32 v68, v68
    v_exp_f32 v69, v69
    v_exp_f32 v70, v70
    v_mfma_f32_32x32x16_bf16 v[76:91], v[32:35], v[60:63], v[76:91]
    v_exp_f32 v71, v71
    v_exp_f32 v72, v72
    v_exp_f32 v73, v73
    v_exp_f32 v74, v74
    v_exp_f32 v75, v75
    v_cvt_pk_bf16_f32 v68, v68, v69
    v_cvt_pk_bf16_f32 v69, v70, v71
    v_cvt_pk_bf16_f32 v70, v72, v73
    v_cvt_pk_bf16_f32 v71, v74, v75
    v_exp_f32 v44, v44
    v_exp_f32 v45, v45
    v_mfma_f32_32x32x16_bf16 v[76:91], v[36:39], v[68:71], v[76:91]
    s_mov_b64 exec, s[36:37]
    ds_read_b128 v[32:35], v6 offset:58368
    ds_read_b128 v[36:39], v6 offset:58880
    s_mov_b64 exec, -1
    v_exp_f32 v46, v46
    v_exp_f32 v47, v47
    v_exp_f32 v48, v48
    v_exp_f32 v49, v49
    v_exp_f32 v50, v50
    s_waitcnt lgkmcnt(2)
    v_mfma_f32_32x32x16_bf16 v[60:75], v[20:23], v[12:15], v[92:107]
    ds_read_b128 v[16:19], v5 offset:59392
    s_waitcnt vmcnt(12)
    v_mfma_f32_32x32x16_bf16 v[108:123], a[88:91], v[40:43], v[108:123]
    v_mfma_f32_32x32x16_bf16 v[108:123], a[92:95], v[40:43], v[108:123]
    v_exp_f32 v51, v51
    v_cvt_pk_bf16_f32 v44, v44, v45
    v_cvt_pk_bf16_f32 v45, v46, v47
    v_cvt_pk_bf16_f32 v46, v48, v49
    v_cvt_pk_bf16_f32 v47, v50, v51
    v_exp_f32 v52, v52
    v_exp_f32 v53, v53
    v_exp_f32 v54, v54
    v_mfma_f32_32x32x16_bf16 v[76:91], v[24:27], v[44:47], v[76:91]
    v_exp_f32 v55, v55
    v_exp_f32 v56, v56
    v_exp_f32 v57, v57
    v_exp_f32 v58, v58
    v_exp_f32 v59, v59
    v_cvt_pk_bf16_f32 v52, v52, v53
    v_cvt_pk_bf16_f32 v53, v54, v55
    v_cvt_pk_bf16_f32 v54, v56, v57
    v_cvt_pk_bf16_f32 v55, v58, v59
    v_exp_f32 v60, v60
    v_exp_f32 v61, v61
    v_mfma_f32_32x32x16_bf16 v[76:91], v[28:31], v[52:55], v[76:91]
    s_mov_b64 exec, s[36:37]
    ds_read_b128 v[24:27], v6 offset:59392
    ds_read_b128 v[28:31], v6 offset:59904
    s_mov_b64 exec, -1
    v_exp_f32 v62, v62
    v_exp_f32 v63, v63
    v_exp_f32 v64, v64
    v_exp_f32 v65, v65
    v_exp_f32 v66, v66
    s_waitcnt lgkmcnt(2)
    v_mfma_f32_32x32x16_bf16 v[44:59], v[16:19], v[12:15], v[92:107]
    ds_read_b128 v[20:23], v5 offset:60416
    v_exp_f32 v67, v67
    v_cvt_pk_bf16_f32 v60, v60, v61
    v_cvt_pk_bf16_f32 v61, v62, v63
    v_cvt_pk_bf16_f32 v62, v64, v65
    v_cvt_pk_bf16_f32 v63, v66, v67
    v_exp_f32 v68, v68
    v_exp_f32 v69, v69
    v_exp_f32 v70, v70
    v_mfma_f32_32x32x16_bf16 v[76:91], v[32:35], v[60:63], v[76:91]
    v_exp_f32 v71, v71
    v_exp_f32 v72, v72
    v_exp_f32 v73, v73
    v_exp_f32 v74, v74
    v_exp_f32 v75, v75
    v_cvt_pk_bf16_f32 v68, v68, v69
    v_cvt_pk_bf16_f32 v69, v70, v71
    v_cvt_pk_bf16_f32 v70, v72, v73
    v_cvt_pk_bf16_f32 v71, v74, v75
    v_exp_f32 v44, v44
    v_exp_f32 v45, v45
    v_mfma_f32_32x32x16_bf16 v[76:91], v[36:39], v[68:71], v[76:91]
    s_mov_b64 exec, s[36:37]
    ds_read_b128 v[32:35], v6 offset:60416
    ds_read_b128 v[36:39], v6 offset:60928
    s_mov_b64 exec, -1
    v_exp_f32 v46, v46
    v_exp_f32 v47, v47
    v_exp_f32 v48, v48
    v_exp_f32 v49, v49
    v_exp_f32 v50, v50
    s_waitcnt lgkmcnt(2)
    v_mfma_f32_32x32x16_bf16 v[60:75], v[20:23], v[12:15], v[92:107]
    ds_read_b128 v[16:19], v5 offset:61440
    s_waitcnt vmcnt(10)
    v_mfma_f32_32x32x16_bf16 v[108:123], a[96:99], v[40:43], v[108:123]
    v_mfma_f32_32x32x16_bf16 v[108:123], a[100:103], v[40:43], v[108:123]
    v_exp_f32 v51, v51
    v_cvt_pk_bf16_f32 v44, v44, v45
    v_cvt_pk_bf16_f32 v45, v46, v47
    v_cvt_pk_bf16_f32 v46, v48, v49
    v_cvt_pk_bf16_f32 v47, v50, v51
    v_exp_f32 v52, v52
    v_exp_f32 v53, v53
    v_exp_f32 v54, v54
    v_mfma_f32_32x32x16_bf16 v[76:91], v[24:27], v[44:47], v[76:91]
    v_exp_f32 v55, v55
    v_exp_f32 v56, v56
    v_exp_f32 v57, v57
    v_exp_f32 v58, v58
    v_exp_f32 v59, v59
    v_cvt_pk_bf16_f32 v52, v52, v53
    v_cvt_pk_bf16_f32 v53, v54, v55
    v_cvt_pk_bf16_f32 v54, v56, v57
    v_cvt_pk_bf16_f32 v55, v58, v59
    v_exp_f32 v60, v60
    v_exp_f32 v61, v61
    v_mfma_f32_32x32x16_bf16 v[76:91], v[28:31], v[52:55], v[76:91]
    s_mov_b64 exec, s[36:37]
    ds_read_b128 v[24:27], v6 offset:61440
    ds_read_b128 v[28:31], v6 offset:61952
    s_mov_b64 exec, -1
    v_exp_f32 v62, v62
    v_exp_f32 v63, v63
    v_exp_f32 v64, v64
    v_exp_f32 v65, v65
    v_exp_f32 v66, v66
    s_waitcnt lgkmcnt(2)
    v_mfma_f32_32x32x16_bf16 v[44:59], v[16:19], v[12:15], v[92:107]
    ds_read_b128 v[20:23], v5 offset:62464
    s_waitcnt vmcnt(7)
    v_mfma_f32_32x32x16_bf16 v[108:123], a[104:107], v[40:43], v[108:123]
    v_mfma_f32_32x32x16_bf16 v[108:123], a[108:111], v[40:43], v[108:123]
    v_exp_f32 v67, v67
    v_cvt_pk_bf16_f32 v60, v60, v61
    v_cvt_pk_bf16_f32 v61, v62, v63
    v_cvt_pk_bf16_f32 v62, v64, v65
    v_cvt_pk_bf16_f32 v63, v66, v67
    v_exp_f32 v68, v68
    v_exp_f32 v69, v69
    v_exp_f32 v70, v70
    v_mfma_f32_32x32x16_bf16 v[76:91], v[32:35], v[60:63], v[76:91]
    v_exp_f32 v71, v71
    v_exp_f32 v72, v72
    v_exp_f32 v73, v73
    v_exp_f32 v74, v74
    v_exp_f32 v75, v75
    v_cvt_pk_bf16_f32 v68, v68, v69
    v_cvt_pk_bf16_f32 v69, v70, v71
    v_cvt_pk_bf16_f32 v70, v72, v73
    v_cvt_pk_bf16_f32 v71, v74, v75
    v_exp_f32 v44, v44
    v_exp_f32 v45, v45
    v_mfma_f32_32x32x16_bf16 v[76:91], v[36:39], v[68:71], v[76:91]
    s_mov_b64 exec, s[36:37]
    ds_read_b128 v[32:35], v6 offset:62464
    ds_read_b128 v[36:39], v6 offset:62976
    s_mov_b64 exec, -1
    v_exp_f32 v46, v46
    v_exp_f32 v47, v47
    v_exp_f32 v48, v48
    v_exp_f32 v49, v49
    v_exp_f32 v50, v50
    s_waitcnt lgkmcnt(2)
    v_mfma_f32_32x32x16_bf16 v[60:75], v[20:23], v[12:15], v[92:107]
    ds_read_b128 v[16:19], v5 offset:63488
    v_exp_f32 v51, v51
    v_cvt_pk_bf16_f32 v44, v44, v45
    v_cvt_pk_bf16_f32 v45, v46, v47
    v_cvt_pk_bf16_f32 v46, v48, v49
    v_cvt_pk_bf16_f32 v47, v50, v51
    v_exp_f32 v52, v52
    v_exp_f32 v53, v53
    v_exp_f32 v54, v54
    v_mfma_f32_32x32x16_bf16 v[76:91], v[24:27], v[44:47], v[76:91]
    v_exp_f32 v55, v55
    v_exp_f32 v56, v56
    v_exp_f32 v57, v57
    v_exp_f32 v58, v58
    v_exp_f32 v59, v59
    v_cvt_pk_bf16_f32 v52, v52, v53
    v_cvt_pk_bf16_f32 v53, v54, v55
    v_cvt_pk_bf16_f32 v54, v56, v57
    v_cvt_pk_bf16_f32 v55, v58, v59
    v_exp_f32 v60, v60
    v_exp_f32 v61, v61
    v_mfma_f32_32x32x16_bf16 v[76:91], v[28:31], v[52:55], v[76:91]
    s_mov_b64 exec, s[36:37]
    ds_read_b128 v[24:27], v6 offset:63488
    ds_read_b128 v[28:31], v6 offset:64000
    s_mov_b64 exec, -1
    v_exp_f32 v62, v62
    v_exp_f32 v63, v63
    v_exp_f32 v64, v64
    v_exp_f32 v65, v65
    v_exp_f32 v66, v66
    s_waitcnt lgkmcnt(2)
    v_mfma_f32_32x32x16_bf16 v[44:59], v[16:19], v[12:15], v[92:107]
    ds_read_b128 v[20:23], v5 offset:64512
    s_waitcnt vmcnt(4)
    v_mfma_f32_32x32x16_bf16 v[108:123], a[112:115], v[40:43], v[108:123]
    v_mfma_f32_32x32x16_bf16 v[108:123], a[116:119], v[40:43], v[108:123]
    v_exp_f32 v67, v67
    v_cvt_pk_bf16_f32 v60, v60, v61
    v_cvt_pk_bf16_f32 v61, v62, v63
    v_cvt_pk_bf16_f32 v62, v64, v65
    v_cvt_pk_bf16_f32 v63, v66, v67
    v_exp_f32 v68, v68
    v_exp_f32 v69, v69
    v_exp_f32 v70, v70
    v_mfma_f32_32x32x16_bf16 v[76:91], v[32:35], v[60:63], v[76:91]
    v_exp_f32 v71, v71
    v_exp_f32 v72, v72
    v_exp_f32 v73, v73
    v_exp_f32 v74, v74
    v_exp_f32 v75, v75
    v_cvt_pk_bf16_f32 v68, v68, v69
    v_cvt_pk_bf16_f32 v69, v70, v71
    v_cvt_pk_bf16_f32 v70, v72, v73
    v_cvt_pk_bf16_f32 v71, v74, v75
    v_exp_f32 v44, v44
    v_exp_f32 v45, v45
    v_mfma_f32_32x32x16_bf16 v[76:91], v[36:39], v[68:71], v[76:91]
    s_mov_b64 exec, s[36:37]
    ds_read_b128 v[32:35], v6 offset:64512
    ds_read_b128 v[36:39], v6 offset:65024
    s_mov_b64 exec, -1
    v_exp_f32 v46, v46
    v_exp_f32 v47, v47
    v_exp_f32 v48, v48
    v_exp_f32 v49, v49
    v_exp_f32 v50, v50
    s_waitcnt lgkmcnt(2)
    v_mfma_f32_32x32x16_bf16 v[60:75], v[20:23], v[12:15], v[92:107]
    v_exp_f32 v51, v51
    v_cvt_pk_bf16_f32 v44, v44, v45
    v_cvt_pk_bf16_f32 v45, v46, v47
    v_cvt_pk_bf16_f32 v46, v48, v49
    v_cvt_pk_bf16_f32 v47, v50, v51
    v_exp_f32 v52, v52
    v_exp_f32 v53, v53
    v_exp_f32 v54, v54
    v_mfma_f32_32x32x16_bf16 v[76:91], v[24:27], v[44:47], v[76:91]
    v_exp_f32 v55, v55
    v_exp_f32 v56, v56
    v_exp_f32 v57, v57
    v_exp_f32 v58, v58
    v_exp_f32 v59, v59
    v_cvt_pk_bf16_f32 v52, v52, v53
    v_cvt_pk_bf16_f32 v53, v54, v55
    v_cvt_pk_bf16_f32 v54, v56, v57
    v_cvt_pk_bf16_f32 v55, v58, v59
    v_exp_f32 v60, v60
    v_exp_f32 v61, v61
    v_mfma_f32_32x32x16_bf16 v[76:91], v[28:31], v[52:55], v[76:91]
    v_exp_f32 v62, v62
    v_exp_f32 v63, v63
    v_exp_f32 v64, v64
    v_exp_f32 v65, v65
    v_exp_f32 v66, v66
    s_waitcnt vmcnt(1)
    v_mfma_f32_32x32x16_bf16 v[108:123], a[120:123], v[40:43], v[108:123]
    v_mfma_f32_32x32x16_bf16 v[108:123], a[124:127], v[40:43], v[108:123]
    v_exp_f32 v67, v67
    v_cvt_pk_bf16_f32 v60, v60, v61
    v_cvt_pk_bf16_f32 v61, v62, v63
    v_cvt_pk_bf16_f32 v62, v64, v65
    v_cvt_pk_bf16_f32 v63, v66, v67
    v_exp_f32 v68, v68
    v_exp_f32 v69, v69
    v_exp_f32 v70, v70
    s_waitcnt lgkmcnt(0)
    v_mfma_f32_32x32x16_bf16 v[76:91], v[32:35], v[60:63], v[76:91]
    v_exp_f32 v71, v71
    v_exp_f32 v72, v72
    v_exp_f32 v73, v73
    v_exp_f32 v74, v74
    v_exp_f32 v75, v75
    v_cvt_pk_bf16_f32 v68, v68, v69
    v_cvt_pk_bf16_f32 v69, v70, v71
    v_cvt_pk_bf16_f32 v70, v72, v73
    v_cvt_pk_bf16_f32 v71, v74, v75
    s_nop 1
    v_mfma_f32_32x32x16_bf16 v[76:91], v[36:39], v[68:71], v[76:91]
    s_branch f_attn_fin
f_slow:
    s_nop 12
    s_add_u32 m0, s39, 8192
    s_add_u32 s41, s40, 8192
    buffer_load_dwordx4 v4, s[20:23], s41 offen lds
    s_add_u32 m0, s39, 73728
    s_add_u32 s41, s40, 2105344
    buffer_load_dwordx4 v4, s[20:23], s41 offen lds
    s_add_u32 m0, s39, 16384
    s_add_u32 s41, s40, 16384
    buffer_load_dwordx4 v4, s[20:23], s41 offen lds
    s_add_u32 m0, s39, 81920
    s_add_u32 s41, s40, 2113536
    buffer_load_dwordx4 v4, s[20:23], s41 offen lds
    s_mov_b32 s16, s30
    s_and_b32 s17, s31, 0xffff
    s_mov_b32 s18, 2097152
    s_mov_b32 s19, 0x20000
    s_mov_b32 s12, s32
    s_and_b32 s13, s33, 0xffff
    s_mov_b32 s14, 2097152
    s_mov_b32 s15, 0x20000
    s_mov_b32 s44, s34
    s_and_b32 s45, s35, 0xffff
    s_mov_b32 s46, 524288
    s_mov_b32 s47, 0x20000
    s_lshl_b32 s41, s2, 3
    s_add_u32 s41, s41, s24
    v_lshrrev_b32 v2, 3, v1
    v_and_b32 v3, 7, v1
    v_bfe_u32 v10, v1, 4, 1
    v_bfe_u32 v11, v1, 2, 2
    v_lshrrev_b32 v124, 5, v1
    v_lshl_add_u32 v11, v124, 2, v11
    v_lshlrev_b32 v124, 7, v11
    v_and_b32 v125, 3, v1
    v_lshl_add_u32 v124, v125, 3, v124
    s_lshl_b32 s31, s24, 12
    s_add_u32 s31, s31, 131072
    v_add_u32 v124, s31, v124
    s_cmp_ge_u32 s41, 896
    s_cbranch_scc1 f_rp_dn1
    s_mov_b32 s48, s4
    s_and_b32 s49, s5, 0xffff
    s_mov_b32 s50, 1835008
    s_mov_b32 s51, 0x20000
    s_mov_b32 s52, s6
    s_and_b32 s53, s7, 0xffff
    s_mov_b32 s54, 1835008
    s_mov_b32 s55, 0x20000
    s_mul_i32 s42, s41, 2341
    s_lshr_b32 s42, s42, 16
    s_mul_i32 s3, s42, 28
    s_sub_u32 s41, s41, s3
    s_mul_i32 s56, s42, 57344
    s_lshl_b32 s3, s41, 7
    s_add_u32 s56, s56, s3
    s_mov_b32 s57, s56
    s_add_u32 s58, s56, 28672
    s_mov_b32 s59, s58
    v_lshlrev_b32 v10, 1, v10
    v_xor_b32 v3, v3, v10
    v_lshlrev_b32 v3, 4, v3
    v_mul_u32_u24 v2, 3584, v2
    v_add_u32 v7, v2, v3
    v_xor_b32 v8, 64, v7
    v_bfe_u32 v2, v1, 3, 2
    v_lshl_add_u32 v124, v2, 5, v124
    v_bfe_u32 v2, v1, 4, 1
    v_lshl_add_u32 v124, v2, 10, v124
    v_xor_b32 v125, 32, v124
    v_xor_b32 v126, 64, v124
    v_xor_b32 v127, 96, v124
    s_lshl_b32 s60, s41, 17
    s_lshl_b32 s3, s42, 10
    s_add_u32 s60, s60, s3
    s_add_u32 s60, s60, 18874368
    s_add_u32 s61, s60, 32768
    s_add_u32 s62, s60, 65536
    s_add_u32 s63, s60, 98304
    s_branch f_rp_set1
f_rp_dn1:
    s_mov_b32 s48, s28
    s_and_b32 s49, s29, 0xffff
    s_mov_b32 s50, 1835008
    s_mov_b32 s51, 0x20000
    s_mov_b32 s52, s28
    s_and_b32 s53, s29, 0xffff
    s_mov_b32 s54, 1835008
    s_mov_b32 s55, 0x20000
    s_sub_u32 s41, s41, 896
    s_lshr_b32 s42, s41, 3
    s_and_b32 s41, s41, 7
    s_lshl_b32 s56, s42, 15
    s_lshl_b32 s3, s41, 7
    s_add_u32 s56, s56, s3
    s_add_u32 s57, s56, 16384
    s_add_u32 s58, s56, 8192
    s_add_u32 s59, s56, 24576
    v_lshlrev_b32 v10, 2, v10
    v_xor_b32 v3, v3, v10
    v_lshlrev_b32 v3, 4, v3
    v_lshl_add_u32 v7, v2, 10, v3
    v_mov_b32 v8, v7
    v_bfe_u32 v2, v1, 3, 1
    v_lshl_add_u32 v124, v2, 6, v124
    v_bfe_u32 v2, v1, 4, 1
    v_lshl_add_u32 v124, v2, 5, v124
    v_add_u32 v125, 1024, v124
    v_xor_b32 v126, 64, v124
    v_xor_b32 v127, 64, v125
    s_mul_i32 s60, s41, 229376
    s_lshl_b32 s3, s42, 11
    s_add_u32 s60, s60, s3
    s_add_u32 s60, s60, 22544384
    s_cmp_ge_u32 s42, 56
    s_cselect_b32 s60, 24379392, s60
    s_add_u32 s61, s60, 1024
    s_add_u32 s62, s60, 114688
    s_add_u32 s63, s60, 115712
f_rp_set1:
    s_and_b32 s28, s26, 15
    s_min_u32 s29, s24, 6
    s_mul_i32 s30, s28, 7
    s_add_u32 s30, s30, s29
    s_lshl_b32 s30, s30, 15
    s_add_u32 s30, s30, 18874368
    v_lshrrev_b32 v2, 3, v1
    v_bfe_u32 v3, v1, 2, 1
    v_bfe_u32 v9, v1, 4, 1
    v_xor_b32 v3, v3, v9
    v_lshlrev_b32 v3, 6, v3
    v_lshl_add_u32 v3, v2, 10, v3
    v_and_b32 v2, 3, v1
    v_lshl_add_u32 v9, v2, 4, v3
    s_and_b32 s29, s26, 7
    s_lshl_b32 s32, s24, 16
    s_lshl_b32 s33, s29, 7
    s_add_u32 s32, s32, s33
    s_and_b32 s33, s24, 3
    s_lshl_b32 s33, s33, 13
    s_lshr_b32 s34, s24, 2
    s_lshl_b32 s34, s34, 16
    s_add_u32 s33, s33, s34
    s_add_u32 m0, s39, 24576
    s_add_u32 s41, s40, 24576
    buffer_load_dwordx4 v4, s[20:23], s41 offen lds
    s_add_u32 m0, s39, 90112
    s_add_u32 s41, s40, 2121728
    buffer_load_dwordx4 v4, s[20:23], s41 offen lds
    s_add_u32 m0, s39, 32768
    s_add_u32 s41, s40, 32768
    buffer_load_dwordx4 v4, s[20:23], s41 offen lds
    s_add_u32 m0, s39, 98304
    s_add_u32 s41, s40, 2129920
    buffer_load_dwordx4 v4, s[20:23], s41 offen lds
    s_add_u32 m0, s39, 40960
    s_add_u32 s41, s40, 40960
    buffer_load_dwordx4 v4, s[20:23], s41 offen lds
    s_add_u32 m0, s39, 106496
    s_add_u32 s41, s40, 2138112
    buffer_load_dwordx4 v4, s[20:23], s41 offen lds
    s_add_u32 m0, s39, 49152
    s_add_u32 s41, s40, 49152
    buffer_load_dwordx4 v4, s[20:23], s41 offen lds
    s_add_u32 m0, s39, 114688
    s_add_u32 s41, s40, 2146304
    buffer_load_dwordx4 v4, s[20:23], s41 offen lds
    s_add_u32 m0, s39, 57344
    s_add_u32 s41, s40, 57344
    buffer_load_dwordx4 v4, s[20:23], s41 offen lds
    s_add_u32 m0, s39, 122880
    s_add_u32 s41, s40, 2154496
    buffer_load_dwordx4 v4, s[20:23], s41 offen lds
    s_add_u32 m0, s31, 0
    s_nop 0
    buffer_load_dwordx4 v7, s[48:51], s56 offen lds
    s_add_u32 m0, s31, 1024
    s_nop 0
    buffer_load_dwordx4 v8, s[52:55], s57 offen lds
    s_add_u32 m0, s31, 2048
    s_nop 0
    buffer_load_dwordx4 v7, s[48:51], s58 offen lds
    s_add_u32 m0, s31, 3072
    s_nop 0
    buffer_load_dwordx4 v8, s[52:55], s59 offen lds
    s_waitcnt vmcnt(0)
    ds_read_b64_tr_b16 a[0:1], v124 offset:0
    ds_read_b64_tr_b16 a[2:3], v124 offset:2048
    ds_read_b64_tr_b16 a[4:5], v125 offset:0
    ds_read_b64_tr_b16 a[6:7], v125 offset:2048
    ds_read_b64_tr_b16 a[8:9], v126 offset:0
    ds_read_b64_tr_b16 a[10:11], v126 offset:2048
    ds_read_b64_tr_b16 a[12:13], v127 offset:0
    ds_read_b64_tr_b16 a[14:15], v127 offset:2048
    s_waitcnt lgkmcnt(0)
    buffer_store_dwordx4 a[0:3], v4, s[20:23], s60 offen sc1
    buffer_store_dwordx4 a[4:7], v4, s[20:23], s61 offen sc1
    buffer_store_dwordx4 a[8:11], v4, s[20:23], s62 offen sc1
    buffer_store_dwordx4 a[12:15], v4, s[20:23], s63 offen sc1
    v_mov_b32 v92, 0xff7fffff
    s_mov_b32 s42, 0
    s_waitcnt vmcnt(0)
f_slow_loop:
    s_and_b32 s41, s42, 7
    s_cmp_lg_u32 s41, 0
    s_cbranch_scc1 f_slow_nb
    s_cmp_lg_u32 s42, 32
    s_cbranch_scc1 f_slow_np
    s_cmp_lg_u32 s24, 0
    s_cbranch_scc1 f_f0b3
    s_mov_b32 s41, 18226176
    s_mov_b32 s3, 0
f_f0p3:
    buffer_load_dwordx4 v[124:127], v4, s[20:23], s41 offen sc1
f_f0q3:
    s_add_u32 s3, s3, 1
    s_waitcnt vmcnt(0)
    v_and_b32 v2, v124, v125
    v_and_b32 v3, v126, v127
    v_and_b32 v2, v2, v3
    v_cmp_ne_u32 vcc, 1, v2
    s_cmp_gt_u32 s3, 0x40000
    s_cbranch_scc1 f_f0b3
    s_cbranch_vccnz f_f0p3
f_f0b3:
f_slow_np:
    s_barrier
    s_cmp_lg_u32 s42, 24
    s_cbranch_scc1 f_slow_nb
    s_cmp_lg_u32 s24, 0
    s_cbranch_scc1 f_f0a4
    s_lshl_b32 s41, s2, 2
    s_add_u32 s41, s41, 18226176
    v_mov_b32 v2, 0
    v_mov_b32 v3, 1
    s_mov_b64 exec, 1
    buffer_store_dword v3, v2, s[20:23], s41 offen sc1
    s_mov_b64 exec, -1
f_f0a4:
f_slow_nb:
    ds_read_b128 v[16:19], v5 offset:0
    s_mov_b64 exec, s[36:37]
    ds_read_b128 v[24:27], v6 offset:0
    ds_read_b128 v[28:31], v6 offset:512
    s_mov_b64 exec, -1
    s_waitcnt lgkmcnt(0)
    v_mfma_f32_32x32x16_bf16 v[44:59], v[16:19], v[12:15], 0
    s_nop 11
    v_max3_f32 v93, v44, v45, v92
    v_max3_f32 v93, v46, v47, v93
    v_max3_f32 v93, v48, v49, v93
    v_max3_f32 v93, v50, v51, v93
    v_max3_f32 v93, v52, v53, v93
    v_max3_f32 v93, v54, v55, v93
    v_max3_f32 v93, v56, v57, v93
    v_max3_f32 v93, v58, v59, v93
    v_mov_b32 v2, v93
    s_nop 1
    v_permlane32_swap_b32 v93, v2
    v_max_f32 v93, v93, v2
    v_sub_f32 v94, v92, v93
    v_exp_f32 v94, v94
    v_mov_b32 v92, v93
    v_sub_f32 v44, v44, v93
    v_sub_f32 v45, v45, v93
    v_sub_f32 v46, v46, v93
    v_sub_f32 v47, v47, v93
    v_sub_f32 v48, v48, v93
    v_sub_f32 v49, v49, v93
    v_sub_f32 v50, v50, v93
    v_sub_f32 v51, v51, v93
    v_sub_f32 v52, v52, v93
    v_sub_f32 v53, v53, v93
    v_sub_f32 v54, v54, v93
    v_sub_f32 v55, v55, v93
    v_sub_f32 v56, v56, v93
    v_sub_f32 v57, v57, v93
    v_sub_f32 v58, v58, v93
    v_sub_f32 v59, v59, v93
    v_exp_f32 v44, v44
    v_exp_f32 v45, v45
    v_exp_f32 v46, v46
    v_exp_f32 v47, v47
    v_exp_f32 v48, v48
    v_exp_f32 v49, v49
    v_exp_f32 v50, v50
    v_exp_f32 v51, v51
    v_exp_f32 v52, v52
    v_exp_f32 v53, v53
    v_exp_f32 v54, v54
    v_exp_f32 v55, v55
    v_exp_f32 v56, v56
    v_exp_f32 v57, v57
    v_exp_f32 v58, v58
    v_exp_f32 v59, v59
    v_mul_f32 v76, v94, v76
    v_mul_f32 v77, v94, v77
    v_mul_f32 v78, v94, v78
    v_mul_f32 v79, v94, v79
    v_mul_f32 v80, v94, v80
    v_mul_f32 v81, v94, v81
    v_mul_f32 v82, v94, v82
    v_mul_f32 v83, v94, v83
    v_mul_f32 v84, v94, v84
    v_cvt_pk_bf16_f32 v44, v44, v45
    v_cvt_pk_bf16_f32 v45, v46, v47
    v_cvt_pk_bf16_f32 v46, v48, v49
    v_cvt_pk_bf16_f32 v47, v50, v51
    v_cvt_pk_bf16_f32 v52, v52, v53
    v_cvt_pk_bf16_f32 v53, v54, v55
    v_cvt_pk_bf16_f32 v54, v56, v57
    v_cvt_pk_bf16_f32 v55, v58, v59
    v_mfma_f32_32x32x16_bf16 v[76:91], v[24:27], v[44:47], v[76:91]
    s_nop 0
    v_mfma_f32_32x32x16_bf16 v[76:91], v[28:31], v[52:55], v[76:91]
    v_add_u32 v5, 1024, v5
    v_add_u32 v6, 1024, v6
    s_add_u32 s42, s42, 1
    s_cmp_lt_u32 s42, 64
    s_nop 12
    s_cbranch_scc1 f_slow_loop
    s_add_u32 m0, s33, 0
    s_add_u32 s41, s32, 0
    buffer_load_dwordx4 v9, s[44:47], s41 offen lds
    s_add_u32 m0, s33, 1024
    s_add_u32 s41, s32, 8192
    buffer_load_dwordx4 v9, s[44:47], s41 offen lds
    s_add_u32 m0, s33, 2048
    s_add_u32 s41, s32, 16384
    buffer_load_dwordx4 v9, s[44:47], s41 offen lds
    s_add_u32 m0, s33, 3072
    s_add_u32 s41, s32, 24576
    buffer_load_dwordx4 v9, s[44:47], s41 offen lds
    s_add_u32 m0, s33, 4096
    s_add_u32 s41, s32, 32768
    buffer_load_dwordx4 v9, s[44:47], s41 offen lds
    s_add_u32 m0, s33, 5120
    s_add_u32 s41, s32, 40960
    buffer_load_dwordx4 v9, s[44:47], s41 offen lds
    s_add_u32 m0, s33, 6144
    s_add_u32 s41, s32, 49152
    buffer_load_dwordx4 v9, s[44:47], s41 offen lds
    s_add_u32 m0, s33, 7168
    s_add_u32 s41, s32, 57344
    buffer_load_dwordx4 v9, s[44:47], s41 offen lds
    s_add_u32 s41, s30, 0
    buffer_load_dwordx4 a[0:3], v4, s[20:23], s41 offen offset:0 sc1
    buffer_load_dwordx4 a[4:7], v4, s[20:23], s41 offen offset:1024 sc1
    s_add_u32 s41, s30, 2048
    buffer_load_dwordx4 a[8:11], v4, s[20:23], s41 offen offset:0 sc1
    buffer_load_dwordx4 a[12:15], v4, s[20:23], s41 offen offset:1024 sc1
    s_add_u32 s41, s30, 4096
    buffer_load_dwordx4 a[16:19], v4, s[20:23], s41 offen offset:0 sc1
    buffer_load_dwordx4 a[20:23], v4, s[20:23], s41 offen offset:1024 sc1
    s_add_u32 s41, s30, 6144
    buffer_load_dwordx4 a[24:27], v4, s[20:23], s41 offen offset:0 sc1
    buffer_load_dwordx4 a[28:31], v4, s[20:23], s41 offen offset:1024 sc1
    s_add_u32 s41, s30, 8192
    buffer_load_dwordx4 a[32:35], v4, s[20:23], s41 offen offset:0 sc1
    buffer_load_dwordx4 a[36:39], v4, s[20:23], s41 offen offset:1024 sc1
    s_add_u32 s41, s30, 10240
    buffer_load_dwordx4 a[40:43], v4, s[20:23], s41 offen offset:0 sc1
    buffer_load_dwordx4 a[44:47], v4, s[20:23], s41 offen offset:1024 sc1
    s_add_u32 s41, s30, 12288
    buffer_load_dwordx4 a[48:51], v4, s[20:23], s41 offen offset:0 sc1
    buffer_load_dwordx4 a[52:55], v4, s[20:23], s41 offen offset:1024 sc1
    s_add_u32 s41, s30, 14336
    buffer_load_dwordx4 a[56:59], v4, s[20:23], s41 offen offset:0 sc1
    buffer_load_dwordx4 a[60:63], v4, s[20:23], s41 offen offset:1024 sc1
    s_add_u32 s41, s30, 16384
    buffer_load_dwordx4 a[64:67], v4, s[20:23], s41 offen offset:0 sc1
    buffer_load_dwordx4 a[68:71], v4, s[20:23], s41 offen offset:1024 sc1
    s_add_u32 s41, s30, 18432
    buffer_load_dwordx4 a[72:75], v4, s[20:23], s41 offen offset:0 sc1
    buffer_load_dwordx4 a[76:79], v4, s[20:23], s41 offen offset:1024 sc1
    s_add_u32 s41, s30, 20480
    buffer_load_dwordx4 a[80:83], v4, s[20:23], s41 offen offset:0 sc1
    buffer_load_dwordx4 a[84:87], v4, s[20:23], s41 offen offset:1024 sc1
    s_add_u32 s41, s30, 22528
    buffer_load_dwordx4 a[88:91], v4, s[20:23], s41 offen offset:0 sc1
    buffer_load_dwordx4 a[92:95], v4, s[20:23], s41 offen offset:1024 sc1
    s_add_u32 s41, s30, 24576
    buffer_load_dwordx4 a[96:99], v4, s[20:23], s41 offen offset:0 sc1
    buffer_load_dwordx4 a[100:103], v4, s[20:23], s41 offen offset:1024 sc1
    s_add_u32 s41, s30, 26624
    buffer_load_dwordx4 a[104:107], v4, s[20:23], s41 offen offset:0 sc1
    buffer_load_dwordx4 a[108:111], v4, s[20:23], s41 offen offset:1024 sc1
    s_add_u32 s41, s30, 28672
    buffer_load_dwordx4 a[112:115], v4, s[20:23], s41 offen offset:0 sc1
    buffer_load_dwordx4 a[116:119], v4, s[20:23], s41 offen offset:1024 sc1
    s_add_u32 s41, s30, 30720
    buffer_load_dwordx4 a[120:123], v4, s[20:23], s41 offen offset:0 sc1
    buffer_load_dwordx4 a[124:127], v4, s[20:23], s41 offen offset:1024 sc1
    s_waitcnt vmcnt(30)
    v_mfma_f32_32x32x16_bf16 v[108:123], a[0:3], v[40:43], v[108:123]
    v_mfma_f32_32x32x16_bf16 v[108:123], a[4:7], v[40:43], v[108:123]
    s_waitcnt vmcnt(28)
    v_mfma_f32_32x32x16_bf16 v[108:123], a[8:11], v[40:43], v[108:123]
    v_mfma_f32_32x32x16_bf16 v[108:123], a[12:15], v[40:43], v[108:123]
    s_waitcnt vmcnt(26)
    v_mfma_f32_32x32x16_bf16 v[108:123], a[16:19], v[40:43], v[108:123]
    v_mfma_f32_32x32x16_bf16 v[108:123], a[20:23], v[40:43], v[108:123]
    s_waitcnt vmcnt(24)
    v_mfma_f32_32x32x16_bf16 v[108:123], a[24:27], v[40:43], v[108:123]
    v_mfma_f32_32x32x16_bf16 v[108:123], a[28:31], v[40:43], v[108:123]
    s_waitcnt vmcnt(22)
    v_mfma_f32_32x32x16_bf16 v[108:123], a[32:35], v[40:43], v[108:123]
    v_mfma_f32_32x32x16_bf16 v[108:123], a[36:39], v[40:43], v[108:123]
    s_waitcnt vmcnt(20)
    v_mfma_f32_32x32x16_bf16 v[108:123], a[40:43], v[40:43], v[108:123]
    v_mfma_f32_32x32x16_bf16 v[108:123], a[44:47], v[40:43], v[108:123]
    s_waitcnt vmcnt(18)
    v_mfma_f32_32x32x16_bf16 v[108:123], a[48:51], v[40:43], v[108:123]
    v_mfma_f32_32x32x16_bf16 v[108:123], a[52:55], v[40:43], v[108:123]
    s_waitcnt vmcnt(16)
    v_mfma_f32_32x32x16_bf16 v[108:123], a[56:59], v[40:43], v[108:123]
    v_mfma_f32_32x32x16_bf16 v[108:123], a[60:63], v[40:43], v[108:123]
    s_waitcnt vmcnt(14)
    v_mfma_f32_32x32x16_bf16 v[108:123], a[64:67], v[40:43], v[108:123]
    v_mfma_f32_32x32x16_bf16 v[108:123], a[68:71], v[40:43], v[108:123]
    s_waitcnt vmcnt(12)
    v_mfma_f32_32x32x16_bf16 v[108:123], a[72:75], v[40:43], v[108:123]
    v_mfma_f32_32x32x16_bf16 v[108:123], a[76:79], v[40:43], v[108:123]
    s_waitcnt vmcnt(10)
    v_mfma_f32_32x32x16_bf16 v[108:123], a[80:83], v[40:43], v[108:123]
    v_mfma_f32_32x32x16_bf16 v[108:123], a[84:87], v[40:43], v[108:123]
    s_waitcnt vmcnt(8)
    v_mfma_f32_32x32x16_bf16 v[108:123], a[88:91], v[40:43], v[108:123]
    v_mfma_f32_32x32x16_bf16 v[108:123], a[92:95], v[40:43], v[108:123]
    s_waitcnt vmcnt(6)
    v_mfma_f32_32x32x16_bf16 v[108:123], a[96:99], v[40:43], v[108:123]
    v_mfma_f32_32x32x16_bf16 v[108:123], a[100:103], v[40:43], v[108:123]
    s_waitcnt vmcnt(4)
    v_mfma_f32_32x32x16_bf16 v[108:123], a[104:107], v[40:43], v[108:123]
    v_mfma_f32_32x32x16_bf16 v[108:123], a[108:111], v[40:43], v[108:123]
    s_waitcnt vmcnt(2)
    v_mfma_f32_32x32x16_bf16 v[108:123], a[112:115], v[40:43], v[108:123]
    v_mfma_f32_32x32x16_bf16 v[108:123], a[116:119], v[40:43], v[108:123]
    s_waitcnt vmcnt(0)
    v_mfma_f32_32x32x16_bf16 v[108:123], a[120:123], v[40:43], v[108:123]
    v_mfma_f32_32x32x16_bf16 v[108:123], a[124:127], v[40:43], v[108:123]
f_attn_fin:
    s_lshl_b32 s41, s27, 5
    s_add_u32 s41, s41, s43
    s_lshr_b32 s40, s27, 3
    s_lshl_b32 s40, s40, 5
    s_add_u32 s40, s40, s43
    s_lshl_b32 s40, s40, 2
    s_add_u32 s40, s40, 18219008
    s_lshl_b32 s41, s41, 10
    s_add_u32 s41, s41, 6291456
    s_waitcnt vmcnt(0)
    s_nop 7
    v_rcp_f32 v2, v84
    s_nop 0
    v_mul_f32 v76, v2, v76
    v_mul_f32 v77, v2, v77
    v_mul_f32 v78, v2, v78
    v_mul_f32 v79, v2, v79
    v_mul_f32 v80, v2, v80
    v_mul_f32 v81, v2, v81
    v_mul_f32 v82, v2, v82
    v_mul_f32 v83, v2, v83
    v_cvt_pk_bf16_f32 v16, v76, v77
    v_cvt_pk_bf16_f32 v17, v78, v79
    v_cvt_pk_bf16_f32 v18, v80, v81
    v_cvt_pk_bf16_f32 v19, v82, v83
    buffer_store_dwordx4 v[16:19], v4, s[20:23], s41 offen sc1
    s_lshl_b32 s38, s25, 1
    s_lshr_b32 s41, s26, 4
    s_add_u32 s38, s38, s41
    s_lshl_b32 s35, s38, 2
    s_bfe_u32 s41, s26, 0x10003
    s_add_u32 s35, s35, s41
    v_lshlrev_b32 v3, 7, v11
    v_bfe_u32 v2, v1, 3, 1
    v_lshl_add_u32 v3, v2, 6, v3
    v_bfe_u32 v2, v1, 4, 1
    v_lshl_add_u32 v3, v2, 5, v3
    v_and_b32 v2, 3, v1
    v_lshl_add_u32 v11, v2, 3, v3
    s_lshr_b32 s41, s24, 2
    s_lshl_b32 s60, s41, 1
    s_add_u32 s60, s60, s35
    s_lshl_b32 s61, s29, 2
    s_and_b32 s41, s24, 3
    s_add_u32 s61, s61, s41
    s_lshl_b32 s62, s60, 5
    s_add_u32 s62, s62, s61
    s_lshl_b32 s63, s60, 15
    s_lshl_b32 s41, s61, 5
    s_add_u32 s63, s63, s41
    v_and_b32 v2, 31, v1
    v_lshrrev_b32 v3, 5, v1
    v_lshlrev_b32 v3, 4, v3
    v_lshl_add_u32 v7, v2, 10, v3
    s_and_b32 s41, s24, 1
    s_lshl_b32 s41, s41, 14
    s_bfe_u32 s42, s24, 0x10001
    s_lshl_b32 s42, s42, 16
    s_add_u32 s41, s41, s42
    v_add_u32 v5, s41, v11
    v_xor_b32 v6, 64, v5
    s_lshl_b32 s39, s60, 15
    s_and_b32 s41, s24, 3
    s_lshl_b32 s41, s41, 13
    s_add_u32 s39, s39, s41
    s_add_u32 s39, s39, 6291456
    buffer_load_dwordx4 v[44:47], v7, s[12:15], s63 offen
    v_mov_b32 v2, 140000
    v_mov_b32 v3, 0
    ds_write_b32 v2, v3 offset:0
    ds_write_b32 v2, v3 offset:4
    ds_write_b32 v2, v3 offset:8
    ds_write_b32 v2, v3 offset:12
    ds_write_b32 v2, v3 offset:16
    s_waitcnt lgkmcnt(0)
    s_barrier
    ds_read_b64_tr_b16 v[48:49], v5 offset:0
    ds_read_b64_tr_b16 v[50:51], v5 offset:1024
    ds_read_b64_tr_b16 v[52:53], v6 offset:0
    ds_read_b64_tr_b16 v[54:55], v6 offset:1024
    s_lshr_b32 s41, s24, 2
    s_lshl_b32 s41, s41, 16
    s_and_b32 s42, s24, 3
    s_lshl_b32 s42, s42, 11
    s_add_u32 s41, s41, s42
    v_add_u32 v10, s41, v4
    s_add_u32 s41, s39, 4096
    s_mov_b32 s42, 0
f_xpoll:
    buffer_load_dwordx4 v[12:15], v4, s[20:23], s39 offen offset:0 sc1
    buffer_load_dwordx4 v[16:19], v4, s[20:23], s39 offen offset:1024 sc1
    buffer_load_dwordx4 v[20:23], v4, s[20:23], s39 offen offset:2048 sc1
    buffer_load_dwordx4 v[24:27], v4, s[20:23], s39 offen offset:3072 sc1
    buffer_load_dwordx4 v[28:31], v4, s[20:23], s41 offen offset:0 sc1
    buffer_load_dwordx4 v[32:35], v4, s[20:23], s41 offen offset:1024 sc1
    buffer_load_dwordx4 v[36:39], v4, s[20:23], s41 offen offset:2048 sc1
    buffer_load_dwordx4 v[40:43], v4, s[20:23], s41 offen offset:3072 sc1
    s_add_u32 s42, s42, 1
    s_waitcnt vmcnt(7)
    v_max_u32 v2, v12, v13
    v_max3_u32 v2, v14, v15, v2
    s_waitcnt vmcnt(6)
    v_max3_u32 v2, v16, v17, v2
    v_max3_u32 v2, v18, v19, v2
    s_waitcnt vmcnt(5)
    v_max3_u32 v2, v20, v21, v2
    v_max3_u32 v2, v22, v23, v2
    s_waitcnt vmcnt(4)
    v_max3_u32 v2, v24, v25, v2
    v_max3_u32 v2, v26, v27, v2
    s_waitcnt vmcnt(3)
    v_max3_u32 v2, v28, v29, v2
    v_max3_u32 v2, v30, v31, v2
    s_waitcnt vmcnt(2)
    v_max3_u32 v2, v32, v33, v2
    v_max3_u32 v2, v34, v35, v2
    s_waitcnt vmcnt(1)
    v_max3_u32 v2, v36, v37, v2
    v_max3_u32 v2, v38, v39, v2
    s_waitcnt vmcnt(0)
    v_max3_u32 v2, v40, v41, v2
    v_max3_u32 v2, v42, v43, v2
    v_cmp_eq_u32 vcc, -1, v2
    s_cmp_gt_u32 s42, 0x8000
    s_cbranch_scc1 f_xok
    s_cbranch_vccz f_xok
    s_sleep 6
    s_branch f_xpoll
f_xok:
    ds_read_b64_tr_b16 v[56:57], v5 offset:2048
    ds_read_b64_tr_b16 v[58:59], v5 offset:3072
    ds_read_b64_tr_b16 v[60:61], v6 offset:2048
    ds_read_b64_tr_b16 v[62:63], v6 offset:3072
    s_waitcnt lgkmcnt(4)
    v_mfma_f32_32x32x16_bf16 v[64:79], v[48:51], v[12:15], 0
    v_mfma_f32_32x32x16_bf16 v[80:95], v[52:55], v[12:15], 0
    ds_read_b64_tr_b16 v[48:49], v5 offset:4096
    ds_read_b64_tr_b16 v[50:51], v5 offset:5120
    ds_read_b64_tr_b16 v[52:53], v6 offset:4096
    ds_read_b64_tr_b16 v[54:55], v6 offset:5120
    s_waitcnt lgkmcnt(4)
    v_mfma_f32_32x32x16_bf16 v[64:79], v[56:59], v[16:19], v[64:79]
    v_mfma_f32_32x32x16_bf16 v[80:95], v[60:63], v[16:19], v[80:95]
    ds_read_b64_tr_b16 v[56:57], v5 offset:6144
    ds_read_b64_tr_b16 v[58:59], v5 offset:7168
    ds_read_b64_tr_b16 v[60:61], v6 offset:6144
    ds_read_b64_tr_b16 v[62:63], v6 offset:7168
    s_waitcnt lgkmcnt(4)
    v_mfma_f32_32x32x16_bf16 v[64:79], v[48:51], v[20:23], v[64:79]
    v_mfma_f32_32x32x16_bf16 v[80:95], v[52:55], v[20:23], v[80:95]
    ds_read_b64_tr_b16 v[48:49], v5 offset:8192
    ds_read_b64_tr_b16 v[50:51], v5 offset:9216
    ds_read_b64_tr_b16 v[52:53], v6 offset:8192
    ds_read_b64_tr_b16 v[54:55], v6 offset:9216
    s_waitcnt lgkmcnt(4)
    v_mfma_f32_32x32x16_bf16 v[64:79], v[56:59], v[24:27], v[64:79]
    v_mfma_f32_32x32x16_bf16 v[80:95], v[60:63], v[24:27], v[80:95]
    ds_read_b64_tr_b16 v[56:57], v5 offset:10240
    ds_read_b64_tr_b16 v[58:59], v5 offset:11264
    ds_read_b64_tr_b16 v[60:61], v6 offset:10240
    ds_read_b64_tr_b16 v[62:63], v6 offset:11264
    s_waitcnt lgkmcnt(4)
    v_mfma_f32_32x32x16_bf16 v[64:79], v[48:51], v[28:31], v[64:79]
    v_mfma_f32_32x32x16_bf16 v[80:95], v[52:55], v[28:31], v[80:95]
    ds_read_b64_tr_b16 v[48:49], v5 offset:12288
    ds_read_b64_tr_b16 v[50:51], v5 offset:13312
    ds_read_b64_tr_b16 v[52:53], v6 offset:12288
    ds_read_b64_tr_b16 v[54:55], v6 offset:13312
    s_waitcnt lgkmcnt(4)
    v_mfma_f32_32x32x16_bf16 v[64:79], v[56:59], v[32:35], v[64:79]
    v_mfma_f32_32x32x16_bf16 v[80:95], v[60:63], v[32:35], v[80:95]
    ds_read_b64_tr_b16 v[56:57], v5 offset:14336
    ds_read_b64_tr_b16 v[58:59], v5 offset:15360
    ds_read_b64_tr_b16 v[60:61], v6 offset:14336
    ds_read_b64_tr_b16 v[62:63], v6 offset:15360
    s_waitcnt lgkmcnt(4)
    v_mfma_f32_32x32x16_bf16 v[64:79], v[48:51], v[36:39], v[64:79]
    v_mfma_f32_32x32x16_bf16 v[80:95], v[52:55], v[36:39], v[80:95]
    s_waitcnt lgkmcnt(0)
    v_mfma_f32_32x32x16_bf16 v[64:79], v[56:59], v[40:43], v[64:79]
    v_mfma_f32_32x32x16_bf16 v[80:95], v[60:63], v[40:43], v[80:95]
    s_nop 10
    ds_write_b128 v10, v[64:67] offset:32768
    ds_write_b128 v10, v[68:71] offset:33792
    ds_write_b128 v10, v[72:75] offset:40960
    ds_write_b128 v10, v[76:79] offset:41984
    ds_write_b128 v10, v[80:83] offset:49152
    ds_write_b128 v10, v[84:87] offset:50176
    ds_write_b128 v10, v[88:91] offset:57344
    ds_write_b128 v10, v[92:95] offset:58368
    s_and_b32 s41, s24, 3
    s_lshl_b32 s41, s41, 13
    s_lshr_b32 s42, s24, 2
    s_lshl_b32 s42, s42, 16
    s_add_u32 s41, s41, s42
    s_add_u32 s41, s41, 32768
    v_permlane32_swap_b32 v44, v46
    v_permlane32_swap_b32 v45, v47
    s_mov_b32 s42, 0xffff0000
    v_lshlrev_b32 v12, 16, v44
    v_and_b32 v13, s42, v44
    v_lshlrev_b32 v14, 16, v45
    v_and_b32 v15, s42, v45
    v_lshlrev_b32 v16, 16, v46
    v_and_b32 v17, s42, v46
    v_lshlrev_b32 v18, 16, v47
    v_and_b32 v19, s42, v47
    s_waitcnt lgkmcnt(0)
    s_barrier
    v_add_u32 v2, s41, v4
    ds_read_b128 v[64:67], v2 offset:0
    ds_read_b128 v[68:71], v2 offset:1024
    ds_read_b128 v[72:75], v2 offset:2048
    ds_read_b128 v[76:79], v2 offset:3072
    ds_read_b128 v[80:83], v2 offset:4096
    ds_read_b128 v[84:87], v2 offset:5120
    ds_read_b128 v[88:91], v2 offset:6144
    ds_read_b128 v[92:95], v2 offset:7168
    s_waitcnt lgkmcnt(4)
    v_pk_add_f32 v[64:65], v[64:65], v[72:73]
    v_pk_add_f32 v[66:67], v[66:67], v[74:75]
    v_pk_add_f32 v[68:69], v[68:69], v[76:77]
    v_pk_add_f32 v[70:71], v[70:71], v[78:79]
    s_waitcnt lgkmcnt(2)
    v_pk_add_f32 v[64:65], v[64:65], v[80:81]
    v_pk_add_f32 v[66:67], v[66:67], v[82:83]
    v_pk_add_f32 v[68:69], v[68:69], v[84:85]
    v_pk_add_f32 v[70:71], v[70:71], v[86:87]
    s_waitcnt lgkmcnt(0)
    v_pk_add_f32 v[64:65], v[64:65], v[88:89]
    v_pk_add_f32 v[66:67], v[66:67], v[90:91]
    v_pk_add_f32 v[68:69], v[68:69], v[92:93]
    v_pk_add_f32 v[70:71], v[70:71], v[94:95]
    v_pk_add_f32 v[12:13], v[12:13], v[64:65]
    v_pk_add_f32 v[14:15], v[14:15], v[66:67]
    v_pk_add_f32 v[16:17], v[16:17], v[68:69]
    v_pk_add_f32 v[18:19], v[18:19], v[70:71]
    v_cvt_pk_bf16_f32 v60, v12, v13
    v_cvt_pk_bf16_f32 v61, v14, v15
    v_cvt_pk_bf16_f32 v62, v16, v17
    v_cvt_pk_bf16_f32 v63, v18, v19
    s_lshl_b32 s41, s62, 10
    s_add_u32 s41, s41, 8388608
    buffer_store_dwordx4 v[60:63], v4, s[20:23], s41 offen sc1
    v_mov_b32 v20, 0
    v_mov_b32 v21, 0
    v_mov_b32 v22, 0x3f803f80
    v_dot2c_f32_bf16 v20, v60, v22
    v_dot2c_f32_bf16 v21, v60, v60
    v_dot2c_f32_bf16 v20, v61, v22
    v_dot2c_f32_bf16 v21, v61, v61
    v_dot2c_f32_bf16 v20, v62, v22
    v_dot2c_f32_bf16 v21, v62, v62
    v_dot2c_f32_bf16 v20, v63, v22
    v_dot2c_f32_bf16 v21, v63, v63
    s_nop 1
    v_mov_b32 v2, v20
    s_nop 1
    v_permlane32_swap_b32 v20, v2
    v_add_f32 v20, v20, v2
    v_mov_b32 v3, v21
    s_nop 1
    v_permlane32_swap_b32 v21, v3
    v_add_f32 v21, v21, v3
    s_lshl_b32 s41, s61, 14
    s_lshl_b32 s42, s60, 8
    s_add_u32 s41, s41, s42
    s_add_u32 s41, s41, 18284544
    v_lshlrev_b32 v2, 3, v1
    s_mov_b32 exec_hi, 0
    buffer_store_dwordx2 v[20:21], v2, s[20:23], s41 offen sc1
    s_mov_b64 exec, -1
    s_mul_i32 s40, s29, 229376
    s_lshl_b32 s41, s24, 14
    s_add_u32 s40, s40, s41
    s_add_u32 s40, s40, 22544384
    s_add_u32 s39, s40, 114688
    v_mov_b32 v44, v108
    v_mov_b32 v45, v109
    v_mov_b32 v46, v110
    v_mov_b32 v47, v111
    v_mov_b32 v48, v112
    v_mov_b32 v49, v113
    v_mov_b32 v50, v114
    v_mov_b32 v51, v115
    v_mov_b32 v52, v116
    v_mov_b32 v53, v117
    v_mov_b32 v54, v118
    v_mov_b32 v55, v119
    v_mov_b32 v56, v120
    v_mov_b32 v57, v121
    v_mov_b32 v58, v122
    v_mov_b32 v59, v123
    s_lshl_b32 s43, s38, 7
    s_add_u32 s43, s43, 18220032
    s_lshl_b32 s31, s28, 2
    s_add_u32 s31, s31, s43
    s_waitcnt vmcnt(0)
    v_mov_b32 v2, 140016
    v_mov_b32 v3, 1
    s_mov_b64 exec, 1
    ds_add_rtn_u32 v3, v2, v3
    s_waitcnt lgkmcnt(0)
    v_readfirstlane_b32 s41, v3
    s_mov_b64 exec, -1
    s_cmp_lg_u32 s41, 7
    s_cbranch_scc1 f_arr4
    v_mov_b32 v2, 0
    v_mov_b32 v3, 1
    s_mov_b64 exec, 1
    buffer_store_dword v3, v2, s[20:23], s31 offen offset:0 sc1
    s_mov_b64 exec, -1
f_arr4:
    s_lshl_b32 s41, s38, 17
    s_lshl_b32 s42, s24, 10
    s_add_u32 s41, s41, s42
    s_add_u32 s3, s41, 8388608
    s_lshl_b32 s41, s24, 12
    v_add_u32 v10, s41, v4
    s_mov_b32 s42, 0
f_hpoll:
    s_add_u32 s41, s3, 0
    buffer_load_dwordx4 v[12:15], v4, s[20:23], s41 offen sc1
    s_add_u32 s41, s3, 32768
    buffer_load_dwordx4 v[16:19], v4, s[20:23], s41 offen sc1
    s_add_u32 s41, s3, 65536
    buffer_load_dwordx4 v[20:23], v4, s[20:23], s41 offen sc1
    s_add_u32 s41, s3, 98304
    buffer_load_dwordx4 v[24:27], v4, s[20:23], s41 offen sc1
    s_add_u32 s42, s42, 1
    s_waitcnt vmcnt(0)
    v_max_u32 v2, v12, v13
    v_max3_u32 v2, v14, v15, v2
    v_max3_u32 v2, v16, v17, v2
    v_max3_u32 v2, v18, v19, v2
    v_max3_u32 v2, v20, v21, v2
    v_max3_u32 v2, v22, v23, v2
    v_max3_u32 v2, v24, v25, v2
    v_max3_u32 v2, v26, v27, v2
    v_cmp_eq_u32 vcc, -1, v2
    s_cmp_gt_u32 s42, 0x8000
    s_cbranch_scc1 f_hok
    s_cbranch_vccz f_hok
    s_sleep 6
    s_branch f_hpoll
f_hok:
    ds_write_b128 v10, v[12:15] offset:0
    ds_write_b128 v10, v[16:19] offset:1024
    ds_write_b128 v10, v[20:23] offset:2048
    ds_write_b128 v10, v[24:27] offset:3072
    s_waitcnt lgkmcnt(0)
    s_barrier
    s_cmp_eq_u32 s24, 7
    s_cbranch_scc1 f_c_loader
    v_add_u32 v10, 65536, v4
    ds_read_b128 v[12:15], v4 offset:0
    ds_read_b128 v[16:19], v4 offset:1024
    ds_read_b128 v[20:23], v4 offset:2048
    ds_read_b128 v[24:27], v4 offset:3072
    s_waitcnt lgkmcnt(3)
    v_mfma_f32_32x32x16_bf16 v[64:79], a[0:3], v[12:15], 0
    ds_read_b128 v[28:31], v4 offset:4096
    s_waitcnt lgkmcnt(3)
    v_mfma_f32_32x32x16_bf16 v[80:95], a[0:3], v[16:19], 0
    ds_read_b128 v[32:35], v4 offset:5120
    s_waitcnt lgkmcnt(3)
    v_mfma_f32_32x32x16_bf16 v[96:111], a[0:3], v[20:23], 0
    ds_read_b128 v[36:39], v4 offset:6144
    s_waitcnt lgkmcnt(3)
    v_mfma_f32_32x32x16_bf16 v[112:127], a[0:3], v[24:27], 0
    ds_read_b128 v[40:43], v4 offset:7168
    s_waitcnt lgkmcnt(3)
    v_mfma_f32_32x32x16_bf16 v[64:79], a[4:7], v[28:31], v[64:79]
    ds_read_b128 v[12:15], v4 offset:8192
    s_waitcnt lgkmcnt(3)
    v_mfma_f32_32x32x16_bf16 v[80:95], a[4:7], v[32:35], v[80:95]
    ds_read_b128 v[16:19], v4 offset:9216
    buffer_load_dwordx4 a[0:3], v4, s[20:23], s40 offen offset:0 sc1
    s_waitcnt lgkmcnt(3)
    v_mfma_f32_32x32x16_bf16 v[96:111], a[4:7], v[36:39], v[96:111]
    ds_read_b128 v[20:23], v4 offset:10240
    s_waitcnt lgkmcnt(3)
    v_mfma_f32_32x32x16_bf16 v[112:127], a[4:7], v[40:43], v[112:127]
    ds_read_b128 v[24:27], v4 offset:11264
    s_waitcnt lgkmcnt(3)
    v_mfma_f32_32x32x16_bf16 v[64:79], a[8:11], v[12:15], v[64:79]
    ds_read_b128 v[28:31], v4 offset:12288
    s_waitcnt lgkmcnt(3)
    v_mfma_f32_32x32x16_bf16 v[80:95], a[8:11], v[16:19], v[80:95]
    ds_read_b128 v[32:35], v4 offset:13312
    buffer_load_dwordx4 a[4:7], v4, s[20:23], s39 offen offset:0 sc1
    s_waitcnt lgkmcnt(3)
    v_mfma_f32_32x32x16_bf16 v[96:111], a[8:11], v[20:23], v[96:111]
    ds_read_b128 v[36:39], v4 offset:14336
    s_waitcnt lgkmcnt(3)
    v_mfma_f32_32x32x16_bf16 v[112:127], a[8:11], v[24:27], v[112:127]
    ds_read_b128 v[40:43], v4 offset:15360
    s_waitcnt lgkmcnt(3)
    v_mfma_f32_32x32x16_bf16 v[64:79], a[12:15], v[28:31], v[64:79]
    ds_read_b128 v[12:15], v4 offset:16384
    s_waitcnt lgkmcnt(3)
    v_mfma_f32_32x32x16_bf16 v[80:95], a[12:15], v[32:35], v[80:95]
    ds_read_b128 v[16:19], v4 offset:17408
    buffer_load_dwordx4 a[8:11], v4, s[20:23], s40 offen offset:1024 sc1
    s_waitcnt lgkmcnt(3)
    v_mfma_f32_32x32x16_bf16 v[96:111], a[12:15], v[36:39], v[96:111]
    ds_read_b128 v[20:23], v4 offset:18432
    s_waitcnt lgkmcnt(3)
    v_mfma_f32_32x32x16_bf16 v[112:127], a[12:15], v[40:43], v[112:127]
    ds_read_b128 v[24:27], v4 offset:19456
    s_waitcnt lgkmcnt(3)
    v_mfma_f32_32x32x16_bf16 v[64:79], a[16:19], v[12:15], v[64:79]
    ds_read_b128 v[28:31], v4 offset:20480
    s_waitcnt lgkmcnt(3)
    v_mfma_f32_32x32x16_bf16 v[80:95], a[16:19], v[16:19], v[80:95]
    ds_read_b128 v[32:35], v4 offset:21504
    buffer_load_dwordx4 a[12:15], v4, s[20:23], s39 offen offset:1024 sc1
    s_waitcnt lgkmcnt(3)
    v_mfma_f32_32x32x16_bf16 v[96:111], a[16:19], v[20:23], v[96:111]
    ds_read_b128 v[36:39], v4 offset:22528
    s_waitcnt lgkmcnt(3)
    v_mfma_f32_32x32x16_bf16 v[112:127], a[16:19], v[24:27], v[112:127]
    ds_read_b128 v[40:43], v4 offset:23552
    s_waitcnt lgkmcnt(3)
    v_mfma_f32_32x32x16_bf16 v[64:79], a[20:23], v[28:31], v[64:79]
    ds_read_b128 v[12:15], v4 offset:24576
    s_waitcnt lgkmcnt(3)
    v_mfma_f32_32x32x16_bf16 v[80:95], a[20:23], v[32:35], v[80:95]
    ds_read_b128 v[16:19], v4 offset:25600
    buffer_load_dwordx4 a[16:19], v4, s[20:23], s40 offen offset:2048 sc1
    s_waitcnt lgkmcnt(3)
    v_mfma_f32_32x32x16_bf16 v[96:111], a[20:23], v[36:39], v[96:111]
    ds_read_b128 v[20:23], v4 offset:26624
    s_waitcnt lgkmcnt(3)
    v_mfma_f32_32x32x16_bf16 v[112:127], a[20:23], v[40:43], v[112:127]
    ds_read_b128 v[24:27], v4 offset:27648
    s_waitcnt lgkmcnt(3)
    v_mfma_f32_32x32x16_bf16 v[64:79], a[24:27], v[12:15], v[64:79]
    ds_read_b128 v[28:31], v4 offset:28672
    s_waitcnt lgkmcnt(3)
    v_mfma_f32_32x32x16_bf16 v[80:95], a[24:27], v[16:19], v[80:95]
    ds_read_b128 v[32:35], v4 offset:29696
    buffer_load_dwordx4 a[20:23], v4, s[20:23], s39 offen offset:2048 sc1
    s_waitcnt lgkmcnt(3)
    v_mfma_f32_32x32x16_bf16 v[96:111], a[24:27], v[20:23], v[96:111]
    ds_read_b128 v[36:39], v4 offset:30720
    s_waitcnt lgkmcnt(3)
    v_mfma_f32_32x32x16_bf16 v[112:127], a[24:27], v[24:27], v[112:127]
    ds_read_b128 v[40:43], v4 offset:31744
    s_waitcnt lgkmcnt(3)
    v_mfma_f32_32x32x16_bf16 v[64:79], a[28:31], v[28:31], v[64:79]
    s_barrier
    ds_read_b128 v[12:15], v4 offset:32768
    s_waitcnt lgkmcnt(3)
    v_mfma_f32_32x32x16_bf16 v[80:95], a[28:31], v[32:35], v[80:95]
    ds_read_b128 v[16:19], v4 offset:33792
    buffer_load_dwordx4 a[24:27], v4, s[20:23], s40 offen offset:3072 sc1
    s_waitcnt lgkmcnt(3)
    v_mfma_f32_32x32x16_bf16 v[96:111], a[28:31], v[36:39], v[96:111]
    ds_read_b128 v[20:23], v4 offset:34816
    s_waitcnt lgkmcnt(3)
    v_mfma_f32_32x32x16_bf16 v[112:127], a[28:31], v[40:43], v[112:127]
    ds_read_b128 v[24:27], v4 offset:35840
    s_waitcnt lgkmcnt(3)
    v_mfma_f32_32x32x16_bf16 v[64:79], a[32:35], v[12:15], v[64:79]
    ds_read_b128 v[28:31], v4 offset:36864
    s_waitcnt lgkmcnt(3)
    v_mfma_f32_32x32x16_bf16 v[80:95], a[32:35], v[16:19], v[80:95]
    ds_read_b128 v[32:35], v4 offset:37888
    buffer_load_dwordx4 a[28:31], v4, s[20:23], s39 offen offset:3072 sc1
    s_waitcnt lgkmcnt(3)
    v_mfma_f32_32x32x16_bf16 v[96:111], a[32:35], v[20:23], v[96:111]
    ds_read_b128 v[36:39], v4 offset:38912
    s_waitcnt lgkmcnt(3)
    v_mfma_f32_32x32x16_bf16 v[112:127], a[32:35], v[24:27], v[112:127]
    ds_read_b128 v[40:43], v4 offset:39936
    s_waitcnt lgkmcnt(3)
    v_mfma_f32_32x32x16_bf16 v[64:79], a[36:39], v[28:31], v[64:79]
    ds_read_b128 v[12:15], v4 offset:40960
    s_waitcnt lgkmcnt(3)
    v_mfma_f32_32x32x16_bf16 v[80:95], a[36:39], v[32:35], v[80:95]
    ds_read_b128 v[16:19], v4 offset:41984
    s_add_u32 s41, s40, 4096
    buffer_load_dwordx4 a[32:35], v4, s[20:23], s41 offen sc1
    s_waitcnt lgkmcnt(3)
    v_mfma_f32_32x32x16_bf16 v[96:111], a[36:39], v[36:39], v[96:111]
    ds_read_b128 v[20:23], v4 offset:43008
    s_waitcnt lgkmcnt(3)
    v_mfma_f32_32x32x16_bf16 v[112:127], a[36:39], v[40:43], v[112:127]
    ds_read_b128 v[24:27], v4 offset:44032
    s_waitcnt lgkmcnt(3)
    v_mfma_f32_32x32x16_bf16 v[64:79], a[40:43], v[12:15], v[64:79]
    ds_read_b128 v[28:31], v4 offset:45056
    s_waitcnt lgkmcnt(3)
    v_mfma_f32_32x32x16_bf16 v[80:95], a[40:43], v[16:19], v[80:95]
    ds_read_b128 v[32:35], v4 offset:46080
    s_add_u32 s41, s39, 4096
    buffer_load_dwordx4 a[36:39], v4, s[20:23], s41 offen sc1
    s_waitcnt lgkmcnt(3)
    v_mfma_f32_32x32x16_bf16 v[96:111], a[40:43], v[20:23], v[96:111]
    ds_read_b128 v[36:39], v4 offset:47104
    s_waitcnt lgkmcnt(3)
    v_mfma_f32_32x32x16_bf16 v[112:127], a[40:43], v[24:27], v[112:127]
    ds_read_b128 v[40:43], v4 offset:48128
    s_waitcnt lgkmcnt(3)
    v_mfma_f32_32x32x16_bf16 v[64:79], a[44:47], v[28:31], v[64:79]
    s_barrier
    ds_read_b128 v[12:15], v4 offset:49152
    s_waitcnt lgkmcnt(3)
    v_mfma_f32_32x32x16_bf16 v[80:95], a[44:47], v[32:35], v[80:95]
    ds_read_b128 v[16:19], v4 offset:50176
    s_add_u32 s41, s40, 5120
    buffer_load_dwordx4 a[40:43], v4, s[20:23], s41 offen sc1
    s_waitcnt lgkmcnt(3)
    v_mfma_f32_32x32x16_bf16 v[96:111], a[44:47], v[36:39], v[96:111]
    ds_read_b128 v[20:23], v4 offset:51200
    s_waitcnt lgkmcnt(3)
    v_mfma_f32_32x32x16_bf16 v[112:127], a[44:47], v[40:43], v[112:127]
    ds_read_b128 v[24:27], v4 offset:52224
    s_waitcnt lgkmcnt(3)
    v_mfma_f32_32x32x16_bf16 v[64:79], a[48:51], v[12:15], v[64:79]
    ds_read_b128 v[28:31], v4 offset:53248
    s_waitcnt lgkmcnt(3)
    v_mfma_f32_32x32x16_bf16 v[80:95], a[48:51], v[16:19], v[80:95]
    ds_read_b128 v[32:35], v4 offset:54272
    s_add_u32 s41, s39, 5120
    buffer_load_dwordx4 a[44:47], v4, s[20:23], s41 offen sc1
    s_waitcnt lgkmcnt(3)
    v_mfma_f32_32x32x16_bf16 v[96:111], a[48:51], v[20:23], v[96:111]
    ds_read_b128 v[36:39], v4 offset:55296
    s_waitcnt lgkmcnt(3)
    v_mfma_f32_32x32x16_bf16 v[112:127], a[48:51], v[24:27], v[112:127]
    ds_read_b128 v[40:43], v4 offset:56320
    s_waitcnt lgkmcnt(3)
    v_mfma_f32_32x32x16_bf16 v[64:79], a[52:55], v[28:31], v[64:79]
    ds_read_b128 v[12:15], v4 offset:57344
    s_waitcnt lgkmcnt(3)
    v_mfma_f32_32x32x16_bf16 v[80:95], a[52:55], v[32:35], v[80:95]
    ds_read_b128 v[16:19], v4 offset:58368
    s_add_u32 s41, s40, 6144
    buffer_load_dwordx4 a[48:51], v4, s[20:23], s41 offen sc1
    s_waitcnt lgkmcnt(3)
    v_mfma_f32_32x32x16_bf16 v[96:111], a[52:55], v[36:39], v[96:111]
    ds_read_b128 v[20:23], v4 offset:59392
    s_waitcnt lgkmcnt(3)
    v_mfma_f32_32x32x16_bf16 v[112:127], a[52:55], v[40:43], v[112:127]
    ds_read_b128 v[24:27], v4 offset:60416
    s_waitcnt lgkmcnt(3)
    v_mfma_f32_32x32x16_bf16 v[64:79], a[56:59], v[12:15], v[64:79]
    ds_read_b128 v[28:31], v4 offset:61440
    s_waitcnt lgkmcnt(3)
    v_mfma_f32_32x32x16_bf16 v[80:95], a[56:59], v[16:19], v[80:95]
    ds_read_b128 v[32:35], v4 offset:62464
    s_add_u32 s41, s39, 6144
    buffer_load_dwordx4 a[52:55], v4, s[20:23], s41 offen sc1
    s_waitcnt lgkmcnt(3)
    v_mfma_f32_32x32x16_bf16 v[96:111], a[56:59], v[20:23], v[96:111]
    ds_read_b128 v[36:39], v4 offset:63488
    s_waitcnt lgkmcnt(3)
    v_mfma_f32_32x32x16_bf16 v[112:127], a[56:59], v[24:27], v[112:127]
    ds_read_b128 v[40:43], v4 offset:64512
    s_waitcnt lgkmcnt(3)
    v_mfma_f32_32x32x16_bf16 v[64:79], a[60:63], v[28:31], v[64:79]
    s_barrier
    ds_read_b128 v[12:15], v10 offset:0
    s_waitcnt lgkmcnt(3)
    v_mfma_f32_32x32x16_bf16 v[80:95], a[60:63], v[32:35], v[80:95]
    ds_read_b128 v[16:19], v10 offset:1024
    s_add_u32 s41, s40, 7168
    buffer_load_dwordx4 a[56:59], v4, s[20:23], s41 offen sc1
    s_waitcnt lgkmcnt(3)
    v_mfma_f32_32x32x16_bf16 v[96:111], a[60:63], v[36:39], v[96:111]
    ds_read_b128 v[20:23], v10 offset:2048
    s_waitcnt lgkmcnt(3)
    v_mfma_f32_32x32x16_bf16 v[112:127], a[60:63], v[40:43], v[112:127]
    ds_read_b128 v[24:27], v10 offset:3072
    s_waitcnt lgkmcnt(3)
    v_mfma_f32_32x32x16_bf16 v[64:79], a[64:67], v[12:15], v[64:79]
    ds_read_b128 v[28:31], v10 offset:4096
    s_waitcnt lgkmcnt(3)
    v_mfma_f32_32x32x16_bf16 v[80:95], a[64:67], v[16:19], v[80:95]
    ds_read_b128 v[32:35], v10 offset:5120
    s_add_u32 s41, s39, 7168
    buffer_load_dwordx4 a[60:63], v4, s[20:23], s41 offen sc1
    s_waitcnt lgkmcnt(3)
    v_mfma_f32_32x32x16_bf16 v[96:111], a[64:67], v[20:23], v[96:111]
    ds_read_b128 v[36:39], v10 offset:6144
    s_waitcnt lgkmcnt(3)
    v_mfma_f32_32x32x16_bf16 v[112:127], a[64:67], v[24:27], v[112:127]
    ds_read_b128 v[40:43], v10 offset:7168
    s_waitcnt lgkmcnt(3)
    v_mfma_f32_32x32x16_bf16 v[64:79], a[68:71], v[28:31], v[64:79]
    ds_read_b128 v[12:15], v10 offset:8192
    s_waitcnt lgkmcnt(3)
    v_mfma_f32_32x32x16_bf16 v[80:95], a[68:71], v[32:35], v[80:95]
    ds_read_b128 v[16:19], v10 offset:9216
    s_add_u32 s41, s40, 8192
    buffer_load_dwordx4 a[64:67], v4, s[20:23], s41 offen sc1
    s_waitcnt lgkmcnt(3)
    v_mfma_f32_32x32x16_bf16 v[96:111], a[68:71], v[36:39], v[96:111]
    ds_read_b128 v[20:23], v10 offset:10240
    s_waitcnt lgkmcnt(3)
    v_mfma_f32_32x32x16_bf16 v[112:127], a[68:71], v[40:43], v[112:127]
    ds_read_b128 v[24:27], v10 offset:11264
    s_waitcnt lgkmcnt(3)
    v_mfma_f32_32x32x16_bf16 v[64:79], a[72:75], v[12:15], v[64:79]
    ds_read_b128 v[28:31], v10 offset:12288
    s_waitcnt lgkmcnt(3)
    v_mfma_f32_32x32x16_bf16 v[80:95], a[72:75], v[16:19], v[80:95]
    ds_read_b128 v[32:35], v10 offset:13312
    s_add_u32 s41, s39, 8192
    buffer_load_dwordx4 a[68:71], v4, s[20:23], s41 offen sc1
    s_waitcnt lgkmcnt(3)
    v_mfma_f32_32x32x16_bf16 v[96:111], a[72:75], v[20:23], v[96:111]
    ds_read_b128 v[36:39], v10 offset:14336
    s_waitcnt lgkmcnt(3)
    v_mfma_f32_32x32x16_bf16 v[112:127], a[72:75], v[24:27], v[112:127]
    ds_read_b128 v[40:43], v10 offset:15360
    s_waitcnt lgkmcnt(3)
    v_mfma_f32_32x32x16_bf16 v[64:79], a[76:79], v[28:31], v[64:79]
    s_barrier
    ds_read_b128 v[12:15], v10 offset:16384
    s_waitcnt lgkmcnt(3)
    v_mfma_f32_32x32x16_bf16 v[80:95], a[76:79], v[32:35], v[80:95]
    ds_read_b128 v[16:19], v10 offset:17408
    s_add_u32 s41, s40, 9216
    buffer_load_dwordx4 a[72:75], v4, s[20:23], s41 offen sc1
    s_waitcnt lgkmcnt(3)
    v_mfma_f32_32x32x16_bf16 v[96:111], a[76:79], v[36:39], v[96:111]
    ds_read_b128 v[20:23], v10 offset:18432
    s_waitcnt lgkmcnt(3)
    v_mfma_f32_32x32x16_bf16 v[112:127], a[76:79], v[40:43], v[112:127]
    ds_read_b128 v[24:27], v10 offset:19456
    s_waitcnt lgkmcnt(3)
    v_mfma_f32_32x32x16_bf16 v[64:79], a[80:83], v[12:15], v[64:79]
    ds_read_b128 v[28:31], v10 offset:20480
    s_waitcnt lgkmcnt(3)
    v_mfma_f32_32x32x16_bf16 v[80:95], a[80:83], v[16:19], v[80:95]
    ds_read_b128 v[32:35], v10 offset:21504
    s_add_u32 s41, s39, 9216
    buffer_load_dwordx4 a[76:79], v4, s[20:23], s41 offen sc1
    s_waitcnt lgkmcnt(3)
    v_mfma_f32_32x32x16_bf16 v[96:111], a[80:83], v[20:23], v[96:111]
    ds_read_b128 v[36:39], v10 offset:22528
    s_waitcnt lgkmcnt(3)
    v_mfma_f32_32x32x16_bf16 v[112:127], a[80:83], v[24:27], v[112:127]
    ds_read_b128 v[40:43], v10 offset:23552
    s_waitcnt lgkmcnt(3)
    v_mfma_f32_32x32x16_bf16 v[64:79], a[84:87], v[28:31], v[64:79]
    ds_read_b128 v[12:15], v10 offset:24576
    s_waitcnt lgkmcnt(3)
    v_mfma_f32_32x32x16_bf16 v[80:95], a[84:87], v[32:35], v[80:95]
    ds_read_b128 v[16:19], v10 offset:25600
    s_add_u32 s41, s40, 10240
    buffer_load_dwordx4 a[80:83], v4, s[20:23], s41 offen sc1
    s_waitcnt lgkmcnt(3)
    v_mfma_f32_32x32x16_bf16 v[96:111], a[84:87], v[36:39], v[96:111]
    ds_read_b128 v[20:23], v10 offset:26624
    s_waitcnt lgkmcnt(3)
    v_mfma_f32_32x32x16_bf16 v[112:127], a[84:87], v[40:43], v[112:127]
    ds_read_b128 v[24:27], v10 offset:27648
    s_waitcnt lgkmcnt(3)
    v_mfma_f32_32x32x16_bf16 v[64:79], a[88:91], v[12:15], v[64:79]
    ds_read_b128 v[28:31], v10 offset:28672
    s_waitcnt lgkmcnt(3)
    v_mfma_f32_32x32x16_bf16 v[80:95], a[88:91], v[16:19], v[80:95]
    ds_read_b128 v[32:35], v10 offset:29696
    s_add_u32 s41, s39, 10240
    buffer_load_dwordx4 a[84:87], v4, s[20:23], s41 offen sc1
    s_waitcnt lgkmcnt(3)
    v_mfma_f32_32x32x16_bf16 v[96:111], a[88:91], v[20:23], v[96:111]
    ds_read_b128 v[36:39], v10 offset:30720
    s_waitcnt lgkmcnt(3)
    v_mfma_f32_32x32x16_bf16 v[112:127], a[88:91], v[24:27], v[112:127]
    ds_read_b128 v[40:43], v10 offset:31744
    s_waitcnt lgkmcnt(3)
    v_mfma_f32_32x32x16_bf16 v[64:79], a[92:95], v[28:31], v[64:79]
    s_barrier
    ds_read_b128 v[12:15], v10 offset:32768
    s_waitcnt lgkmcnt(3)
    v_mfma_f32_32x32x16_bf16 v[80:95], a[92:95], v[32:35], v[80:95]
    ds_read_b128 v[16:19], v10 offset:33792
    s_add_u32 s41, s40, 11264
    buffer_load_dwordx4 a[88:91], v4, s[20:23], s41 offen sc1
    s_waitcnt lgkmcnt(3)
    v_mfma_f32_32x32x16_bf16 v[96:111], a[92:95], v[36:39], v[96:111]
    ds_read_b128 v[20:23], v10 offset:34816
    s_waitcnt lgkmcnt(3)
    v_mfma_f32_32x32x16_bf16 v[112:127], a[92:95], v[40:43], v[112:127]
    ds_read_b128 v[24:27], v10 offset:35840
    s_waitcnt lgkmcnt(3)
    v_mfma_f32_32x32x16_bf16 v[64:79], a[96:99], v[12:15], v[64:79]
    ds_read_b128 v[28:31], v10 offset:36864
    s_waitcnt lgkmcnt(3)
    v_mfma_f32_32x32x16_bf16 v[80:95], a[96:99], v[16:19], v[80:95]
    ds_read_b128 v[32:35], v10 offset:37888
    s_add_u32 s41, s39, 11264
    buffer_load_dwordx4 a[92:95], v4, s[20:23], s41 offen sc1
    s_waitcnt lgkmcnt(3)
    v_mfma_f32_32x32x16_bf16 v[96:111], a[96:99], v[20:23], v[96:111]
    ds_read_b128 v[36:39], v10 offset:38912
    s_waitcnt lgkmcnt(3)
    v_mfma_f32_32x32x16_bf16 v[112:127], a[96:99], v[24:27], v[112:127]
    ds_read_b128 v[40:43], v10 offset:39936
    s_waitcnt lgkmcnt(3)
    v_mfma_f32_32x32x16_bf16 v[64:79], a[100:103], v[28:31], v[64:79]
    ds_read_b128 v[12:15], v10 offset:40960
    s_waitcnt lgkmcnt(3)
    v_mfma_f32_32x32x16_bf16 v[80:95], a[100:103], v[32:35], v[80:95]
    ds_read_b128 v[16:19], v10 offset:41984
    s_add_u32 s41, s40, 12288
    buffer_load_dwordx4 a[96:99], v4, s[20:23], s41 offen sc1
    s_waitcnt lgkmcnt(3)
    v_mfma_f32_32x32x16_bf16 v[96:111], a[100:103], v[36:39], v[96:111]
    ds_read_b128 v[20:23], v10 offset:43008
    s_waitcnt lgkmcnt(3)
    v_mfma_f32_32x32x16_bf16 v[112:127], a[100:103], v[40:43], v[112:127]
    ds_read_b128 v[24:27], v10 offset:44032
    s_waitcnt lgkmcnt(3)
    v_mfma_f32_32x32x16_bf16 v[64:79], a[104:107], v[12:15], v[64:79]
    ds_read_b128 v[28:31], v10 offset:45056
    s_waitcnt lgkmcnt(3)
    v_mfma_f32_32x32x16_bf16 v[80:95], a[104:107], v[16:19], v[80:95]
    ds_read_b128 v[32:35], v10 offset:46080
    s_add_u32 s41, s39, 12288
    buffer_load_dwordx4 a[100:103], v4, s[20:23], s41 offen sc1
    s_waitcnt lgkmcnt(3)
    v_mfma_f32_32x32x16_bf16 v[96:111], a[104:107], v[20:23], v[96:111]
    ds_read_b128 v[36:39], v10 offset:47104
    s_waitcnt lgkmcnt(3)
    v_mfma_f32_32x32x16_bf16 v[112:127], a[104:107], v[24:27], v[112:127]
    ds_read_b128 v[40:43], v10 offset:48128
    s_waitcnt lgkmcnt(3)
    v_mfma_f32_32x32x16_bf16 v[64:79], a[108:111], v[28:31], v[64:79]
    s_barrier
    ds_read_b128 v[12:15], v10 offset:49152
    s_waitcnt lgkmcnt(3)
    v_mfma_f32_32x32x16_bf16 v[80:95], a[108:111], v[32:35], v[80:95]
    ds_read_b128 v[16:19], v10 offset:50176
    s_add_u32 s41, s40, 13312
    buffer_load_dwordx4 a[104:107], v4, s[20:23], s41 offen sc1
    s_waitcnt lgkmcnt(3)
    v_mfma_f32_32x32x16_bf16 v[96:111], a[108:111], v[36:39], v[96:111]
    ds_read_b128 v[20:23], v10 offset:51200
    s_waitcnt lgkmcnt(3)
    v_mfma_f32_32x32x16_bf16 v[112:127], a[108:111], v[40:43], v[112:127]
    ds_read_b128 v[24:27], v10 offset:52224
    s_waitcnt lgkmcnt(3)
    v_mfma_f32_32x32x16_bf16 v[64:79], a[112:115], v[12:15], v[64:79]
    ds_read_b128 v[28:31], v10 offset:53248
    s_waitcnt lgkmcnt(3)
    v_mfma_f32_32x32x16_bf16 v[80:95], a[112:115], v[16:19], v[80:95]
    ds_read_b128 v[32:35], v10 offset:54272
    s_add_u32 s41, s39, 13312
    buffer_load_dwordx4 a[108:111], v4, s[20:23], s41 offen sc1
    s_waitcnt lgkmcnt(3)
    v_mfma_f32_32x32x16_bf16 v[96:111], a[112:115], v[20:23], v[96:111]
    ds_read_b128 v[36:39], v10 offset:55296
    s_waitcnt lgkmcnt(3)
    v_mfma_f32_32x32x16_bf16 v[112:127], a[112:115], v[24:27], v[112:127]
    ds_read_b128 v[40:43], v10 offset:56320
    s_waitcnt lgkmcnt(3)
    v_mfma_f32_32x32x16_bf16 v[64:79], a[116:119], v[28:31], v[64:79]
    ds_read_b128 v[12:15], v10 offset:57344
    s_waitcnt lgkmcnt(3)
    v_mfma_f32_32x32x16_bf16 v[80:95], a[116:119], v[32:35], v[80:95]
    ds_read_b128 v[16:19], v10 offset:58368
    s_add_u32 s41, s40, 14336
    buffer_load_dwordx4 a[112:115], v4, s[20:23], s41 offen sc1
    s_waitcnt lgkmcnt(3)
    v_mfma_f32_32x32x16_bf16 v[96:111], a[116:119], v[36:39], v[96:111]
    ds_read_b128 v[20:23], v10 offset:59392
    s_waitcnt lgkmcnt(3)
    v_mfma_f32_32x32x16_bf16 v[112:127], a[116:119], v[40:43], v[112:127]
    ds_read_b128 v[24:27], v10 offset:60416
    s_waitcnt lgkmcnt(3)
    v_mfma_f32_32x32x16_bf16 v[64:79], a[120:123], v[12:15], v[64:79]
    ds_read_b128 v[28:31], v10 offset:61440
    s_waitcnt lgkmcnt(3)
    v_mfma_f32_32x32x16_bf16 v[80:95], a[120:123], v[16:19], v[80:95]
    ds_read_b128 v[32:35], v10 offset:62464
    s_add_u32 s41, s39, 14336
    buffer_load_dwordx4 a[116:119], v4, s[20:23], s41 offen sc1
    s_waitcnt lgkmcnt(3)
    v_mfma_f32_32x32x16_bf16 v[96:111], a[120:123], v[20:23], v[96:111]
    ds_read_b128 v[36:39], v10 offset:63488
    s_waitcnt lgkmcnt(3)
    v_mfma_f32_32x32x16_bf16 v[112:127], a[120:123], v[24:27], v[112:127]
    ds_read_b128 v[40:43], v10 offset:64512
    s_waitcnt lgkmcnt(3)
    v_mfma_f32_32x32x16_bf16 v[64:79], a[124:127], v[28:31], v[64:79]
    s_waitcnt lgkmcnt(2)
    v_mfma_f32_32x32x16_bf16 v[80:95], a[124:127], v[32:35], v[80:95]
    s_add_u32 s41, s40, 15360
    buffer_load_dwordx4 a[120:123], v4, s[20:23], s41 offen sc1
    s_waitcnt lgkmcnt(1)
    v_mfma_f32_32x32x16_bf16 v[96:111], a[124:127], v[36:39], v[96:111]
    s_waitcnt lgkmcnt(0)
    v_mfma_f32_32x32x16_bf16 v[112:127], a[124:127], v[40:43], v[112:127]
    v_and_b32 v2, 31, v1
    v_lshlrev_b32 v2, 5, v2
    v_add_u32 v10, 159744, v2
    ds_read_b128 v[28:31], v10 offset:0
    ds_read_b128 v[32:35], v10 offset:16
    ds_read_b128 v[36:39], v10 offset:1024
    ds_read_b128 v[40:43], v10 offset:1040
    s_mul_i32 s42, s28, 7
    s_add_u32 s42, s42, s24
    s_lshl_b32 s41, s38, 2
    s_mul_i32 s43, s41, 112
    s_add_u32 s43, s43, s42
    s_lshl_b32 s43, s43, 10
    s_add_u32 s43, s43, 10485760
    s_lshl_b32 s31, s38, 8
    s_lshl_b32 s41, s28, 2
    s_add_u32 s31, s31, s41
    s_add_u32 s31, s31, 18222080
    s_add_u32 s41, s39, 15360
    buffer_load_dwordx4 a[124:127], v4, s[20:23], s41 offen sc1
    s_waitcnt lgkmcnt(0)
    s_setprio 1
    v_pk_fma_f32 v[64:65], v[44:45], v[28:29], v[64:65]
    v_pk_fma_f32 v[66:67], v[46:47], v[28:29], v[66:67]
    v_pk_fma_f32 v[68:69], v[48:49], v[28:29], v[68:69]
    v_pk_fma_f32 v[70:71], v[50:51], v[28:29], v[70:71]
    v_pk_fma_f32 v[72:73], v[52:53], v[28:29], v[72:73]
    v_pk_fma_f32 v[74:75], v[54:55], v[28:29], v[74:75]
    v_pk_fma_f32 v[76:77], v[56:57], v[28:29], v[76:77]
    v_pk_fma_f32 v[78:79], v[58:59], v[28:29], v[78:79]
    v_pk_mul_f32 v[12:13], v[64:65], v[64:65]
    v_pk_mul_f32 v[14:15], v[66:67], v[66:67]
    v_pk_mul_f32 v[16:17], v[68:69], v[68:69]
    v_pk_mul_f32 v[18:19], v[70:71], v[70:71]
    v_pk_fma_f32 v[12:13], v[12:13], v[32:33], v[34:35]
    v_pk_fma_f32 v[14:15], v[14:15], v[32:33], v[34:35]
    v_pk_fma_f32 v[16:17], v[16:17], v[32:33], v[34:35]
    v_pk_fma_f32 v[18:19], v[18:19], v[32:33], v[34:35]
    v_pk_mul_f32 v[12:13], v[12:13], v[64:65]
    v_pk_mul_f32 v[14:15], v[14:15], v[66:67]
    v_pk_mul_f32 v[16:17], v[16:17], v[68:69]
    v_pk_mul_f32 v[18:19], v[18:19], v[70:71]
    v_exp_f32 v12, v12
    v_exp_f32 v13, v13
    v_exp_f32 v14, v14
    v_exp_f32 v15, v15
    v_exp_f32 v16, v16
    v_exp_f32 v17, v17
    v_exp_f32 v18, v18
    v_exp_f32 v19, v19
    v_pk_mul_f32 v[64:65], v[64:65], v[72:73]
    v_pk_mul_f32 v[66:67], v[66:67], v[74:75]
    v_pk_mul_f32 v[68:69], v[68:69], v[76:77]
    v_pk_mul_f32 v[70:71], v[70:71], v[78:79]
    v_pk_fma_f32 v[12:13], v[12:13], v[30:31], v[30:31]
    v_pk_fma_f32 v[14:15], v[14:15], v[30:31], v[30:31]
    v_pk_fma_f32 v[16:17], v[16:17], v[30:31], v[30:31]
    v_pk_fma_f32 v[18:19], v[18:19], v[30:31], v[30:31]
    ds_read_b128 v[28:31], v10 offset:2048
    ds_read_b128 v[32:35], v10 offset:2064
    v_rcp_f32 v12, v12
    v_rcp_f32 v13, v13
    v_rcp_f32 v14, v14
    v_rcp_f32 v15, v15
    v_rcp_f32 v16, v16
    v_rcp_f32 v17, v17
    v_rcp_f32 v18, v18
    v_rcp_f32 v19, v19
    v_pk_mul_f32 v[64:65], v[64:65], v[12:13]
    v_pk_mul_f32 v[66:67], v[66:67], v[14:15]
    v_pk_mul_f32 v[68:69], v[68:69], v[16:17]
    v_pk_mul_f32 v[70:71], v[70:71], v[18:19]
    v_cvt_pk_bf16_f32 v72, v64, v65
    v_cvt_pk_bf16_f32 v73, v66, v67
    v_cvt_pk_bf16_f32 v74, v68, v69
    v_cvt_pk_bf16_f32 v75, v70, v71
    buffer_store_dwordx4 v[72:75], v4, s[20:23], s43 offen sc1
    s_add_u32 s43, s43, 114688
    v_pk_fma_f32 v[80:81], v[44:45], v[36:37], v[80:81]
    v_pk_fma_f32 v[82:83], v[46:47], v[36:37], v[82:83]
    v_pk_fma_f32 v[84:85], v[48:49], v[36:37], v[84:85]
    v_pk_fma_f32 v[86:87], v[50:51], v[36:37], v[86:87]
    v_pk_fma_f32 v[88:89], v[52:53], v[36:37], v[88:89]
    v_pk_fma_f32 v[90:91], v[54:55], v[36:37], v[90:91]
    v_pk_fma_f32 v[92:93], v[56:57], v[36:37], v[92:93]
    v_pk_fma_f32 v[94:95], v[58:59], v[36:37], v[94:95]
    v_pk_mul_f32 v[20:21], v[80:81], v[80:81]
    v_pk_mul_f32 v[22:23], v[82:83], v[82:83]
    v_pk_mul_f32 v[24:25], v[84:85], v[84:85]
    v_pk_mul_f32 v[26:27], v[86:87], v[86:87]
    v_pk_fma_f32 v[20:21], v[20:21], v[40:41], v[42:43]
    v_pk_fma_f32 v[22:23], v[22:23], v[40:41], v[42:43]
    v_pk_fma_f32 v[24:25], v[24:25], v[40:41], v[42:43]
    v_pk_fma_f32 v[26:27], v[26:27], v[40:41], v[42:43]
    v_pk_mul_f32 v[20:21], v[20:21], v[80:81]
    v_pk_mul_f32 v[22:23], v[22:23], v[82:83]
    v_pk_mul_f32 v[24:25], v[24:25], v[84:85]
    v_pk_mul_f32 v[26:27], v[26:27], v[86:87]
    v_exp_f32 v20, v20
    v_exp_f32 v21, v21
    v_exp_f32 v22, v22
    v_exp_f32 v23, v23
    v_exp_f32 v24, v24
    v_exp_f32 v25, v25
    v_exp_f32 v26, v26
    v_exp_f32 v27, v27
    v_pk_mul_f32 v[80:81], v[80:81], v[88:89]
    v_pk_mul_f32 v[82:83], v[82:83], v[90:91]
    v_pk_mul_f32 v[84:85], v[84:85], v[92:93]
    v_pk_mul_f32 v[86:87], v[86:87], v[94:95]
    v_pk_fma_f32 v[20:21], v[20:21], v[38:39], v[38:39]
    v_pk_fma_f32 v[22:23], v[22:23], v[38:39], v[38:39]
    v_pk_fma_f32 v[24:25], v[24:25], v[38:39], v[38:39]
    v_pk_fma_f32 v[26:27], v[26:27], v[38:39], v[38:39]
    ds_read_b128 v[36:39], v10 offset:3072
    ds_read_b128 v[40:43], v10 offset:3088
    v_rcp_f32 v20, v20
    v_rcp_f32 v21, v21
    v_rcp_f32 v22, v22
    v_rcp_f32 v23, v23
    v_rcp_f32 v24, v24
    v_rcp_f32 v25, v25
    v_rcp_f32 v26, v26
    v_rcp_f32 v27, v27
    v_pk_mul_f32 v[80:81], v[80:81], v[20:21]
    v_pk_mul_f32 v[82:83], v[82:83], v[22:23]
    v_pk_mul_f32 v[84:85], v[84:85], v[24:25]
    v_pk_mul_f32 v[86:87], v[86:87], v[26:27]
    v_cvt_pk_bf16_f32 v88, v80, v81
    v_cvt_pk_bf16_f32 v89, v82, v83
    v_cvt_pk_bf16_f32 v90, v84, v85
    v_cvt_pk_bf16_f32 v91, v86, v87
    buffer_store_dwordx4 v[88:91], v4, s[20:23], s43 offen sc1
    s_add_u32 s43, s43, 114688
    s_setprio 0
    s_waitcnt lgkmcnt(0)
    v_pk_fma_f32 v[96:97], v[44:45], v[28:29], v[96:97]
    v_pk_fma_f32 v[98:99], v[46:47], v[28:29], v[98:99]
    v_pk_fma_f32 v[100:101], v[48:49], v[28:29], v[100:101]
    v_pk_fma_f32 v[102:103], v[50:51], v[28:29], v[102:103]
    v_pk_fma_f32 v[104:105], v[52:53], v[28:29], v[104:105]
    v_pk_fma_f32 v[106:107], v[54:55], v[28:29], v[106:107]
    v_pk_fma_f32 v[108:109], v[56:57], v[28:29], v[108:109]
    v_pk_fma_f32 v[110:111], v[58:59], v[28:29], v[110:111]
    v_pk_mul_f32 v[12:13], v[96:97], v[96:97]
    v_pk_mul_f32 v[14:15], v[98:99], v[98:99]
    v_pk_mul_f32 v[16:17], v[100:101], v[100:101]
    v_pk_mul_f32 v[18:19], v[102:103], v[102:103]
    v_pk_fma_f32 v[12:13], v[12:13], v[32:33], v[34:35]
    v_pk_fma_f32 v[14:15], v[14:15], v[32:33], v[34:35]
    v_pk_fma_f32 v[16:17], v[16:17], v[32:33], v[34:35]
    v_pk_fma_f32 v[18:19], v[18:19], v[32:33], v[34:35]
    v_pk_mul_f32 v[12:13], v[12:13], v[96:97]
    v_pk_mul_f32 v[14:15], v[14:15], v[98:99]
    v_pk_mul_f32 v[16:17], v[16:17], v[100:101]
    v_pk_mul_f32 v[18:19], v[18:19], v[102:103]
    v_exp_f32 v12, v12
    v_exp_f32 v13, v13
    v_exp_f32 v14, v14
    v_exp_f32 v15, v15
    v_exp_f32 v16, v16
    v_exp_f32 v17, v17
    v_exp_f32 v18, v18
    v_exp_f32 v19, v19
    v_pk_mul_f32 v[96:97], v[96:97], v[104:105]
    v_pk_mul_f32 v[98:99], v[98:99], v[106:107]
    v_pk_mul_f32 v[100:101], v[100:101], v[108:109]
    v_pk_mul_f32 v[102:103], v[102:103], v[110:111]
    v_pk_fma_f32 v[12:13], v[12:13], v[30:31], v[30:31]
    v_pk_fma_f32 v[14:15], v[14:15], v[30:31], v[30:31]
    v_pk_fma_f32 v[16:17], v[16:17], v[30:31], v[30:31]
    v_pk_fma_f32 v[18:19], v[18:19], v[30:31], v[30:31]
    v_rcp_f32 v12, v12
    v_rcp_f32 v13, v13
    v_rcp_f32 v14, v14
    v_rcp_f32 v15, v15
    v_rcp_f32 v16, v16
    v_rcp_f32 v17, v17
    v_rcp_f32 v18, v18
    v_rcp_f32 v19, v19
    v_pk_mul_f32 v[96:97], v[96:97], v[12:13]
    v_pk_mul_f32 v[98:99], v[98:99], v[14:15]
    v_pk_mul_f32 v[100:101], v[100:101], v[16:17]
    v_pk_mul_f32 v[102:103], v[102:103], v[18:19]
    v_cvt_pk_bf16_f32 v104, v96, v97
    v_cvt_pk_bf16_f32 v105, v98, v99
    v_cvt_pk_bf16_f32 v106, v100, v101
    v_cvt_pk_bf16_f32 v107, v102, v103
    buffer_store_dwordx4 v[104:107], v4, s[20:23], s43 offen sc1
    s_add_u32 s43, s43, 114688
    s_waitcnt lgkmcnt(0)
    v_pk_fma_f32 v[112:113], v[44:45], v[36:37], v[112:113]
    v_pk_fma_f32 v[114:115], v[46:47], v[36:37], v[114:115]
    v_pk_fma_f32 v[116:117], v[48:49], v[36:37], v[116:117]
    v_pk_fma_f32 v[118:119], v[50:51], v[36:37], v[118:119]
    v_pk_fma_f32 v[120:121], v[52:53], v[36:37], v[120:121]
    v_pk_fma_f32 v[122:123], v[54:55], v[36:37], v[122:123]
    v_pk_fma_f32 v[124:125], v[56:57], v[36:37], v[124:125]
    v_pk_fma_f32 v[126:127], v[58:59], v[36:37], v[126:127]
    v_pk_mul_f32 v[20:21], v[112:113], v[112:113]
    v_pk_mul_f32 v[22:23], v[114:115], v[114:115]
    v_pk_mul_f32 v[24:25], v[116:117], v[116:117]
    v_pk_mul_f32 v[26:27], v[118:119], v[118:119]
    v_pk_fma_f32 v[20:21], v[20:21], v[40:41], v[42:43]
    v_pk_fma_f32 v[22:23], v[22:23], v[40:41], v[42:43]
    v_pk_fma_f32 v[24:25], v[24:25], v[40:41], v[42:43]
    v_pk_fma_f32 v[26:27], v[26:27], v[40:41], v[42:43]
    v_pk_mul_f32 v[20:21], v[20:21], v[112:113]
    v_pk_mul_f32 v[22:23], v[22:23], v[114:115]
    v_pk_mul_f32 v[24:25], v[24:25], v[116:117]
    v_pk_mul_f32 v[26:27], v[26:27], v[118:119]
    v_exp_f32 v20, v20
    v_exp_f32 v21, v21
    v_exp_f32 v22, v22
    v_exp_f32 v23, v23
    v_exp_f32 v24, v24
    v_exp_f32 v25, v25
    v_exp_f32 v26, v26
    v_exp_f32 v27, v27
    v_pk_mul_f32 v[112:113], v[112:113], v[120:121]
    v_pk_mul_f32 v[114:115], v[114:115], v[122:123]
    v_pk_mul_f32 v[116:117], v[116:117], v[124:125]
    v_pk_mul_f32 v[118:119], v[118:119], v[126:127]
    v_pk_fma_f32 v[20:21], v[20:21], v[38:39], v[38:39]
    v_pk_fma_f32 v[22:23], v[22:23], v[38:39], v[38:39]
    v_pk_fma_f32 v[24:25], v[24:25], v[38:39], v[38:39]
    v_pk_fma_f32 v[26:27], v[26:27], v[38:39], v[38:39]
    v_rcp_f32 v20, v20
    v_rcp_f32 v21, v21
    v_rcp_f32 v22, v22
    v_rcp_f32 v23, v23
    v_rcp_f32 v24, v24
    v_rcp_f32 v25, v25
    v_rcp_f32 v26, v26
    v_rcp_f32 v27, v27
    v_pk_mul_f32 v[112:113], v[112:113], v[20:21]
    v_pk_mul_f32 v[114:115], v[114:115], v[22:23]
    v_pk_mul_f32 v[116:117], v[116:117], v[24:25]
    v_pk_mul_f32 v[118:119], v[118:119], v[26:27]
    v_cvt_pk_bf16_f32 v120, v112, v113
    v_cvt_pk_bf16_f32 v121, v114, v115
    v_cvt_pk_bf16_f32 v122, v116, v117
    v_cvt_pk_bf16_f32 v123, v118, v119
    s_waitcnt vmcnt(1)
    v_mov_b32 v2, 140000
    v_mov_b32 v3, 1
    s_mov_b64 exec, 1
    ds_add_rtn_u32 v3, v2, v3
    s_waitcnt lgkmcnt(0)
    v_readfirstlane_b32 s41, v3
    s_mov_b64 exec, -1
    s_cmp_lg_u32 s41, 6
    s_cbranch_scc1 f_arr0
    v_mov_b32 v2, 0
    v_mov_b32 v3, 1
    s_mov_b64 exec, 1
    buffer_store_dword v3, v2, s[20:23], s31 offen offset:0 sc1
    s_mov_b64 exec, -1
f_arr0:
    buffer_store_dwordx4 v[120:123], v4, s[20:23], s43 offen sc1
    s_mul_i32 s39, s35, 114688
    s_lshl_b32 s41, s24, 14
    s_add_u32 s39, s39, s41
    s_add_u32 s39, s39, 10485760
    s_lshl_b32 s41, s24, 11
    v_add_u32 v10, s41, v4
    v_add_u32 v5, 65536, v10
    s_waitcnt vmcnt(0)
    v_mov_b32 v2, 140004
    v_mov_b32 v3, 1
    s_mov_b64 exec, 1
    ds_add_rtn_u32 v3, v2, v3
    s_waitcnt lgkmcnt(0)
    v_readfirstlane_b32 s41, v3
    s_mov_b64 exec, -1
    s_cmp_lg_u32 s41, 6
    s_cbranch_scc1 f_arr1
    v_mov_b32 v2, 0
    v_mov_b32 v3, 1
    s_mov_b64 exec, 1
    buffer_store_dword v3, v2, s[20:23], s31 offen offset:128 sc1
    s_mov_b64 exec, -1
f_arr1:
    v_mov_b32 v2, 140000
    s_mov_b32 s42, 0
f_go0:
    ds_read_b32 v3, v2 offset:8
    s_add_u32 s42, s42, 1
    s_waitcnt lgkmcnt(0)
    v_readfirstlane_b32 s3, v3
    s_cmp_gt_u32 s42, 0x1000000
    s_cbranch_scc1 f_goo0
    s_cmp_eq_u32 s3, 0
    s_cbranch_scc1 f_go0
f_goo0:
    s_add_u32 s41, s39, 0
    buffer_load_dwordx4 v[12:15], v4, s[20:23], s41 offen offset:0 sc1
    buffer_load_dwordx4 v[16:19], v4, s[20:23], s41 offen offset:1024 sc1
    buffer_load_dwordx4 v[20:23], v4, s[20:23], s41 offen offset:2048 sc1
    buffer_load_dwordx4 v[24:27], v4, s[20:23], s41 offen offset:3072 sc1
    s_add_u32 s41, s39, 4096
    buffer_load_dwordx4 v[28:31], v4, s[20:23], s41 offen offset:0 sc1
    buffer_load_dwordx4 v[32:35], v4, s[20:23], s41 offen offset:1024 sc1
    buffer_load_dwordx4 v[36:39], v4, s[20:23], s41 offen offset:2048 sc1
    buffer_load_dwordx4 v[40:43], v4, s[20:23], s41 offen offset:3072 sc1
    s_add_u32 s41, s39, 8192
    buffer_load_dwordx4 v[44:47], v4, s[20:23], s41 offen offset:0 sc1
    buffer_load_dwordx4 v[48:51], v4, s[20:23], s41 offen offset:1024 sc1
    buffer_load_dwordx4 v[52:55], v4, s[20:23], s41 offen offset:2048 sc1
    buffer_load_dwordx4 v[56:59], v4, s[20:23], s41 offen offset:3072 sc1
    s_waitcnt vmcnt(11)
    v_mfma_f32_32x32x16_bf16 v[64:79], a[0:3], v[12:15], 0
    v_mfma_f32_32x32x16_bf16 v[80:95], a[4:7], v[12:15], 0
    s_add_u32 s41, s39, 12288
    buffer_load_dwordx4 v[12:15], v4, s[20:23], s41 offen offset:0 sc1
    s_waitcnt vmcnt(11)
    v_mfma_f32_32x32x16_bf16 v[64:79], a[8:11], v[16:19], v[64:79]
    v_mfma_f32_32x32x16_bf16 v[80:95], a[12:15], v[16:19], v[80:95]
    buffer_load_dwordx4 v[16:19], v4, s[20:23], s41 offen offset:1024 sc1
    s_waitcnt vmcnt(11)
    v_mfma_f32_32x32x16_bf16 v[64:79], a[16:19], v[20:23], v[64:79]
    v_mfma_f32_32x32x16_bf16 v[80:95], a[20:23], v[20:23], v[80:95]
    buffer_load_dwordx4 v[20:23], v4, s[20:23], s41 offen offset:2048 sc1
    s_waitcnt vmcnt(11)
    v_mfma_f32_32x32x16_bf16 v[64:79], a[24:27], v[24:27], v[64:79]
    v_mfma_f32_32x32x16_bf16 v[80:95], a[28:31], v[24:27], v[80:95]
    buffer_load_dwordx4 v[24:27], v4, s[20:23], s41 offen offset:3072 sc1
    s_waitcnt vmcnt(11)
    v_mfma_f32_32x32x16_bf16 v[64:79], a[32:35], v[28:31], v[64:79]
    v_mfma_f32_32x32x16_bf16 v[80:95], a[36:39], v[28:31], v[80:95]
    v_mov_b32 v2, 140000
    s_mov_b32 s42, 0
f_go1:
    ds_read_b32 v3, v2 offset:12
    s_add_u32 s42, s42, 1
    s_waitcnt lgkmcnt(0)
    v_readfirstlane_b32 s3, v3
    s_cmp_gt_u32 s42, 0x1000000
    s_cbranch_scc1 f_goo1
    s_cmp_eq_u32 s3, 0
    s_cbranch_scc1 f_go1
f_goo1:
    s_add_u32 s41, s39, 229376
    buffer_load_dwordx4 v[28:31], v4, s[20:23], s41 offen offset:0 sc1
    s_waitcnt vmcnt(11)
    v_mfma_f32_32x32x16_bf16 v[64:79], a[40:43], v[32:35], v[64:79]
    v_mfma_f32_32x32x16_bf16 v[80:95], a[44:47], v[32:35], v[80:95]
    buffer_load_dwordx4 v[32:35], v4, s[20:23], s41 offen offset:1024 sc1
    s_waitcnt vmcnt(11)
    v_mfma_f32_32x32x16_bf16 v[64:79], a[48:51], v[36:39], v[64:79]
    v_mfma_f32_32x32x16_bf16 v[80:95], a[52:55], v[36:39], v[80:95]
    buffer_load_dwordx4 v[36:39], v4, s[20:23], s41 offen offset:2048 sc1
    s_waitcnt vmcnt(11)
    v_mfma_f32_32x32x16_bf16 v[64:79], a[56:59], v[40:43], v[64:79]
    v_mfma_f32_32x32x16_bf16 v[80:95], a[60:63], v[40:43], v[80:95]
    buffer_load_dwordx4 v[40:43], v4, s[20:23], s41 offen offset:3072 sc1
    s_waitcnt vmcnt(11)
    v_mfma_f32_32x32x16_bf16 v[64:79], a[64:67], v[44:47], v[64:79]
    v_mfma_f32_32x32x16_bf16 v[80:95], a[68:71], v[44:47], v[80:95]
    s_add_u32 s41, s39, 233472
    buffer_load_dwordx4 v[44:47], v4, s[20:23], s41 offen offset:0 sc1
    s_waitcnt vmcnt(11)
    v_mfma_f32_32x32x16_bf16 v[64:79], a[72:75], v[48:51], v[64:79]
    v_mfma_f32_32x32x16_bf16 v[80:95], a[76:79], v[48:51], v[80:95]
    buffer_load_dwordx4 v[48:51], v4, s[20:23], s41 offen offset:1024 sc1
    s_waitcnt vmcnt(11)
    v_mfma_f32_32x32x16_bf16 v[64:79], a[80:83], v[52:55], v[64:79]
    v_mfma_f32_32x32x16_bf16 v[80:95], a[84:87], v[52:55], v[80:95]
    buffer_load_dwordx4 v[52:55], v4, s[20:23], s41 offen offset:2048 sc1
    s_waitcnt vmcnt(11)
    v_mfma_f32_32x32x16_bf16 v[64:79], a[88:91], v[56:59], v[64:79]
    v_mfma_f32_32x32x16_bf16 v[80:95], a[92:95], v[56:59], v[80:95]
    buffer_load_dwordx4 v[56:59], v4, s[20:23], s41 offen offset:3072 sc1
    s_waitcnt vmcnt(11)
    v_mfma_f32_32x32x16_bf16 v[64:79], a[96:99], v[12:15], v[64:79]
    v_mfma_f32_32x32x16_bf16 v[80:95], a[100:103], v[12:15], v[80:95]
    s_add_u32 s41, s39, 237568
    buffer_load_dwordx4 v[12:15], v4, s[20:23], s41 offen offset:0 sc1
    s_waitcnt vmcnt(11)
    v_mfma_f32_32x32x16_bf16 v[64:79], a[104:107], v[16:19], v[64:79]
    v_mfma_f32_32x32x16_bf16 v[80:95], a[108:111], v[16:19], v[80:95]
    buffer_load_dwordx4 v[16:19], v4, s[20:23], s41 offen offset:1024 sc1
    s_waitcnt vmcnt(11)
    v_mfma_f32_32x32x16_bf16 v[64:79], a[112:115], v[20:23], v[64:79]
    v_mfma_f32_32x32x16_bf16 v[80:95], a[116:119], v[20:23], v[80:95]
    buffer_load_dwordx4 v[20:23], v4, s[20:23], s41 offen offset:2048 sc1
    s_waitcnt vmcnt(11)
    v_mfma_f32_32x32x16_bf16 v[64:79], a[120:123], v[24:27], v[64:79]
    v_mfma_f32_32x32x16_bf16 v[80:95], a[124:127], v[24:27], v[80:95]
    buffer_load_dwordx4 v[24:27], v4, s[20:23], s41 offen offset:3072 sc1
    s_waitcnt vmcnt(11)
    v_mfma_f32_32x32x16_bf16 v[96:111], a[0:3], v[28:31], 0
    v_mfma_f32_32x32x16_bf16 v[112:127], a[4:7], v[28:31], 0
    s_add_u32 s41, s39, 241664
    buffer_load_dwordx4 v[28:31], v4, s[20:23], s41 offen offset:0 sc1
    s_waitcnt vmcnt(11)
    v_mfma_f32_32x32x16_bf16 v[96:111], a[8:11], v[32:35], v[96:111]
    v_mfma_f32_32x32x16_bf16 v[112:127], a[12:15], v[32:35], v[112:127]
    buffer_load_dwordx4 v[32:35], v4, s[20:23], s41 offen offset:1024 sc1
    s_waitcnt vmcnt(11)
    v_mfma_f32_32x32x16_bf16 v[96:111], a[16:19], v[36:39], v[96:111]
    v_mfma_f32_32x32x16_bf16 v[112:127], a[20:23], v[36:39], v[112:127]
    buffer_load_dwordx4 v[36:39], v4, s[20:23], s41 offen offset:2048 sc1
    ds_write_b128 v10, v[64:67] offset:0
    s_waitcnt vmcnt(11)
    v_mfma_f32_32x32x16_bf16 v[96:111], a[24:27], v[40:43], v[96:111]
    v_mfma_f32_32x32x16_bf16 v[112:127], a[28:31], v[40:43], v[112:127]
    buffer_load_dwordx4 v[40:43], v4, s[20:23], s41 offen offset:3072 sc1
    ds_write_b128 v10, v[68:71] offset:1024
    s_waitcnt vmcnt(11)
    v_mfma_f32_32x32x16_bf16 v[96:111], a[32:35], v[44:47], v[96:111]
    v_mfma_f32_32x32x16_bf16 v[112:127], a[36:39], v[44:47], v[112:127]
    ds_write_b128 v10, v[72:75] offset:14336
    s_waitcnt vmcnt(10)
    v_mfma_f32_32x32x16_bf16 v[96:111], a[40:43], v[48:51], v[96:111]
    v_mfma_f32_32x32x16_bf16 v[112:127], a[44:47], v[48:51], v[112:127]
    ds_write_b128 v10, v[76:79] offset:15360
    s_waitcnt vmcnt(9)
    v_mfma_f32_32x32x16_bf16 v[96:111], a[48:51], v[52:55], v[96:111]
    v_mfma_f32_32x32x16_bf16 v[112:127], a[52:55], v[52:55], v[112:127]
    ds_write_b128 v10, v[80:83] offset:28672
    s_waitcnt vmcnt(8)
    v_mfma_f32_32x32x16_bf16 v[96:111], a[56:59], v[56:59], v[96:111]
    v_mfma_f32_32x32x16_bf16 v[112:127], a[60:63], v[56:59], v[112:127]
    ds_write_b128 v10, v[84:87] offset:29696
    s_waitcnt vmcnt(7)
    v_mfma_f32_32x32x16_bf16 v[96:111], a[64:67], v[12:15], v[96:111]
    v_mfma_f32_32x32x16_bf16 v[112:127], a[68:71], v[12:15], v[112:127]
    ds_write_b128 v10, v[88:91] offset:43008
    s_waitcnt vmcnt(6)
    v_mfma_f32_32x32x16_bf16 v[96:111], a[72:75], v[16:19], v[96:111]
    v_mfma_f32_32x32x16_bf16 v[112:127], a[76:79], v[16:19], v[112:127]
    ds_write_b128 v10, v[92:95] offset:44032
    s_waitcnt vmcnt(5)
    v_mfma_f32_32x32x16_bf16 v[96:111], a[80:83], v[20:23], v[96:111]
    v_mfma_f32_32x32x16_bf16 v[112:127], a[84:87], v[20:23], v[112:127]
    s_waitcnt vmcnt(4)
    v_mfma_f32_32x32x16_bf16 v[96:111], a[88:91], v[24:27], v[96:111]
    v_mfma_f32_32x32x16_bf16 v[112:127], a[92:95], v[24:27], v[112:127]
    s_waitcnt vmcnt(3)
    v_mfma_f32_32x32x16_bf16 v[96:111], a[96:99], v[28:31], v[96:111]
    v_mfma_f32_32x32x16_bf16 v[112:127], a[100:103], v[28:31], v[112:127]
    s_waitcnt vmcnt(2)
    v_mfma_f32_32x32x16_bf16 v[96:111], a[104:107], v[32:35], v[96:111]
    v_mfma_f32_32x32x16_bf16 v[112:127], a[108:111], v[32:35], v[112:127]
    s_waitcnt vmcnt(1)
    v_mfma_f32_32x32x16_bf16 v[96:111], a[112:115], v[36:39], v[96:111]
    v_mfma_f32_32x32x16_bf16 v[112:127], a[116:119], v[36:39], v[112:127]
    s_waitcnt vmcnt(0)
    v_mfma_f32_32x32x16_bf16 v[96:111], a[120:123], v[40:43], v[96:111]
    v_mfma_f32_32x32x16_bf16 v[112:127], a[124:127], v[40:43], v[112:127]
    s_nop 10
    ds_write_b128 v10, v[96:99] offset:57344
    ds_write_b128 v10, v[100:103] offset:58368
    ds_write_b128 v5, v[104:107] offset:6144
    ds_write_b128 v5, v[108:111] offset:7168
    ds_write_b128 v5, v[112:115] offset:20480
    ds_write_b128 v5, v[116:119] offset:21504
    ds_write_b128 v5, v[120:123] offset:34816
    ds_write_b128 v5, v[124:127] offset:35840
    s_branch f_d_fin
f_c_loader:
    v_and_b32 v10, 15, v1
    v_lshlrev_b32 v10, 2, v10
    s_mov_b32 s42, 0
f_poll0:
    s_sleep 4
    buffer_load_dword v24, v10, s[20:23], s43 offen offset:0 sc1
    s_add_u32 s42, s42, 1
    s_waitcnt vmcnt(0)
    v_cmp_ne_u32 vcc, 1, v24
    s_cmp_gt_u32 s42, 0x40000
    s_cbranch_scc1 f_pout0
    s_cbranch_vccnz f_poll0
f_pout0:
    s_lshl_b32 s40, s38, 17
    s_add_u32 s40, s40, 8388608
    s_lshl_b32 s39, s38, 10
    s_add_u32 s39, s39, 18284544
    s_mov_b32 m0, 32768
    s_add_u32 s41, s40, 8192
    buffer_load_dwordx4 v4, s[20:23], s41 offen sc1 lds
    s_mov_b32 m0, 33792
    s_add_u32 s41, s40, 40960
    buffer_load_dwordx4 v4, s[20:23], s41 offen sc1 lds
    s_mov_b32 m0, 34816
    s_add_u32 s41, s40, 73728
    buffer_load_dwordx4 v4, s[20:23], s41 offen sc1 lds
    s_mov_b32 m0, 35840
    s_add_u32 s41, s40, 106496
    buffer_load_dwordx4 v4, s[20:23], s41 offen sc1 lds
    s_mov_b32 m0, 36864
    s_add_u32 s41, s40, 9216
    buffer_load_dwordx4 v4, s[20:23], s41 offen sc1 lds
    s_mov_b32 m0, 37888
    s_add_u32 s41, s40, 41984
    buffer_load_dwordx4 v4, s[20:23], s41 offen sc1 lds
    s_mov_b32 m0, 38912
    s_add_u32 s41, s40, 74752
    buffer_load_dwordx4 v4, s[20:23], s41 offen sc1 lds
    s_mov_b32 m0, 39936
    s_add_u32 s41, s40, 107520
    buffer_load_dwordx4 v4, s[20:23], s41 offen sc1 lds
    s_mov_b32 m0, 40960
    s_add_u32 s41, s40, 10240
    buffer_load_dwordx4 v4, s[20:23], s41 offen sc1 lds
    s_mov_b32 m0, 41984
    s_add_u32 s41, s40, 43008
    buffer_load_dwordx4 v4, s[20:23], s41 offen sc1 lds
    s_mov_b32 m0, 43008
    s_add_u32 s41, s40, 75776
    buffer_load_dwordx4 v4, s[20:23], s41 offen sc1 lds
    s_mov_b32 m0, 44032
    s_add_u32 s41, s40, 108544
    buffer_load_dwordx4 v4, s[20:23], s41 offen sc1 lds
    s_mov_b32 m0, 45056
    s_add_u32 s41, s40, 11264
    buffer_load_dwordx4 v4, s[20:23], s41 offen sc1 lds
    s_mov_b32 m0, 46080
    s_add_u32 s41, s40, 44032
    buffer_load_dwordx4 v4, s[20:23], s41 offen sc1 lds
    s_mov_b32 m0, 47104
    s_add_u32 s41, s40, 76800
    buffer_load_dwordx4 v4, s[20:23], s41 offen sc1 lds
    s_mov_b32 m0, 48128
    s_add_u32 s41, s40, 109568
    buffer_load_dwordx4 v4, s[20:23], s41 offen sc1 lds
    s_mov_b32 m0, 49152
    s_add_u32 s41, s40, 12288
    buffer_load_dwordx4 v4, s[20:23], s41 offen sc1 lds
    s_mov_b32 m0, 50176
    s_add_u32 s41, s40, 45056
    buffer_load_dwordx4 v4, s[20:23], s41 offen sc1 lds
    s_mov_b32 m0, 51200
    s_add_u32 s41, s40, 77824
    buffer_load_dwordx4 v4, s[20:23], s41 offen sc1 lds
    s_mov_b32 m0, 52224
    s_add_u32 s41, s40, 110592
    buffer_load_dwordx4 v4, s[20:23], s41 offen sc1 lds
    s_mov_b32 m0, 53248
    s_add_u32 s41, s40, 13312
    buffer_load_dwordx4 v4, s[20:23], s41 offen sc1 lds
    s_mov_b32 m0, 54272
    s_add_u32 s41, s40, 46080
    buffer_load_dwordx4 v4, s[20:23], s41 offen sc1 lds
    s_mov_b32 m0, 55296
    s_add_u32 s41, s40, 78848
    buffer_load_dwordx4 v4, s[20:23], s41 offen sc1 lds
    s_mov_b32 m0, 56320
    s_add_u32 s41, s40, 111616
    buffer_load_dwordx4 v4, s[20:23], s41 offen sc1 lds
    s_mov_b32 m0, 57344
    s_add_u32 s41, s40, 14336
    buffer_load_dwordx4 v4, s[20:23], s41 offen sc1 lds
    s_mov_b32 m0, 58368
    s_add_u32 s41, s40, 47104
    buffer_load_dwordx4 v4, s[20:23], s41 offen sc1 lds
    s_mov_b32 m0, 59392
    s_add_u32 s41, s40, 79872
    buffer_load_dwordx4 v4, s[20:23], s41 offen sc1 lds
    s_mov_b32 m0, 60416
    s_add_u32 s41, s40, 112640
    buffer_load_dwordx4 v4, s[20:23], s41 offen sc1 lds
    s_mov_b32 m0, 61440
    s_add_u32 s41, s40, 15360
    buffer_load_dwordx4 v4, s[20:23], s41 offen sc1 lds
    s_mov_b32 m0, 62464
    s_add_u32 s41, s40, 48128
    buffer_load_dwordx4 v4, s[20:23], s41 offen sc1 lds
    s_mov_b32 m0, 63488
    s_add_u32 s41, s40, 80896
    buffer_load_dwordx4 v4, s[20:23], s41 offen sc1 lds
    s_mov_b32 m0, 64512
    s_add_u32 s41, s40, 113664
    buffer_load_dwordx4 v4, s[20:23], s41 offen sc1 lds
    s_waitcnt vmcnt(16)
    s_barrier
    s_mov_b32 m0, 65536
    s_add_u32 s41, s40, 16384
    buffer_load_dwordx4 v4, s[20:23], s41 offen sc1 lds
    s_mov_b32 m0, 66560
    s_add_u32 s41, s40, 49152
    buffer_load_dwordx4 v4, s[20:23], s41 offen sc1 lds
    s_mov_b32 m0, 67584
    s_add_u32 s41, s40, 81920
    buffer_load_dwordx4 v4, s[20:23], s41 offen sc1 lds
    s_mov_b32 m0, 68608
    s_add_u32 s41, s40, 114688
    buffer_load_dwordx4 v4, s[20:23], s41 offen sc1 lds
    s_mov_b32 m0, 69632
    s_add_u32 s41, s40, 17408
    buffer_load_dwordx4 v4, s[20:23], s41 offen sc1 lds
    s_mov_b32 m0, 70656
    s_add_u32 s41, s40, 50176
    buffer_load_dwordx4 v4, s[20:23], s41 offen sc1 lds
    s_mov_b32 m0, 71680
    s_add_u32 s41, s40, 82944
    buffer_load_dwordx4 v4, s[20:23], s41 offen sc1 lds
    s_mov_b32 m0, 72704
    s_add_u32 s41, s40, 115712
    buffer_load_dwordx4 v4, s[20:23], s41 offen sc1 lds
    s_mov_b32 m0, 73728
    s_add_u32 s41, s40, 18432
    buffer_load_dwordx4 v4, s[20:23], s41 offen sc1 lds
    s_mov_b32 m0, 74752
    s_add_u32 s41, s40, 51200
    buffer_load_dwordx4 v4, s[20:23], s41 offen sc1 lds
    s_mov_b32 m0, 75776
    s_add_u32 s41, s40, 83968
    buffer_load_dwordx4 v4, s[20:23], s41 offen sc1 lds
    s_mov_b32 m0, 76800
    s_add_u32 s41, s40, 116736
    buffer_load_dwordx4 v4, s[20:23], s41 offen sc1 lds
    s_mov_b32 m0, 77824
    s_add_u32 s41, s40, 19456
    buffer_load_dwordx4 v4, s[20:23], s41 offen sc1 lds
    s_mov_b32 m0, 78848
    s_add_u32 s41, s40, 52224
    buffer_load_dwordx4 v4, s[20:23], s41 offen sc1 lds
    s_mov_b32 m0, 79872
    s_add_u32 s41, s40, 84992
    buffer_load_dwordx4 v4, s[20:23], s41 offen sc1 lds
    s_mov_b32 m0, 80896
    s_add_u32 s41, s40, 117760
    buffer_load_dwordx4 v4, s[20:23], s41 offen sc1 lds
    s_add_u32 s41, s39, 0
    buffer_load_dwordx4 v[64:67], v4, s[20:23], s41 offen sc1
    s_add_u32 s41, s39, 16384
    buffer_load_dwordx4 v[68:71], v4, s[20:23], s41 offen sc1
    s_add_u32 s41, s39, 32768
    buffer_load_dwordx4 v[72:75], v4, s[20:23], s41 offen sc1
    s_add_u32 s41, s39, 49152
    buffer_load_dwordx4 v[76:79], v4, s[20:23], s41 offen sc1
    s_add_u32 s41, s39, 65536
    buffer_load_dwordx4 v[80:83], v4, s[20:23], s41 offen sc1
    s_add_u32 s41, s39, 81920
    buffer_load_dwordx4 v[84:87], v4, s[20:23], s41 offen sc1
    s_add_u32 s41, s39, 98304
    buffer_load_dwordx4 v[88:91], v4, s[20:23], s41 offen sc1
    s_add_u32 s41, s39, 114688
    buffer_load_dwordx4 v[92:95], v4, s[20:23], s41 offen sc1
    s_add_u32 s41, s39, 131072
    buffer_load_dwordx4 v[96:99], v4, s[20:23], s41 offen sc1
    s_add_u32 s41, s39, 147456
    buffer_load_dwordx4 v[100:103], v4, s[20:23], s41 offen sc1
    s_add_u32 s41, s39, 163840
    buffer_load_dwordx4 v[104:107], v4, s[20:23], s41 offen sc1
    s_add_u32 s41, s39, 180224
    buffer_load_dwordx4 v[108:111], v4, s[20:23], s41 offen sc1
    s_add_u32 s41, s39, 196608
    buffer_load_dwordx4 v[112:115], v4, s[20:23], s41 offen sc1
    s_add_u32 s41, s39, 212992
    buffer_load_dwordx4 v[116:119], v4, s[20:23], s41 offen sc1
    s_add_u32 s41, s39, 229376
    buffer_load_dwordx4 v[120:123], v4, s[20:23], s41 offen sc1
    s_add_u32 s41, s39, 245760
    buffer_load_dwordx4 v[124:127], v4, s[20:23], s41 offen sc1
    s_waitcnt vmcnt(32)
    s_barrier
    s_mov_b32 m0, 81920
    s_add_u32 s41, s40, 20480
    buffer_load_dwordx4 v4, s[20:23], s41 offen sc1 lds
    s_mov_b32 m0, 82944
    s_add_u32 s41, s40, 53248
    buffer_load_dwordx4 v4, s[20:23], s41 offen sc1 lds
    s_mov_b32 m0, 83968
    s_add_u32 s41, s40, 86016
    buffer_load_dwordx4 v4, s[20:23], s41 offen sc1 lds
    s_mov_b32 m0, 84992
    s_add_u32 s41, s40, 118784
    buffer_load_dwordx4 v4, s[20:23], s41 offen sc1 lds
    s_mov_b32 m0, 86016
    s_add_u32 s41, s40, 21504
    buffer_load_dwordx4 v4, s[20:23], s41 offen sc1 lds
    s_mov_b32 m0, 87040
    s_add_u32 s41, s40, 54272
    buffer_load_dwordx4 v4, s[20:23], s41 offen sc1 lds
    s_mov_b32 m0, 88064
    s_add_u32 s41, s40, 87040
    buffer_load_dwordx4 v4, s[20:23], s41 offen sc1 lds
    s_mov_b32 m0, 89088
    s_add_u32 s41, s40, 119808
    buffer_load_dwordx4 v4, s[20:23], s41 offen sc1 lds
    s_mov_b32 m0, 90112
    s_add_u32 s41, s40, 22528
    buffer_load_dwordx4 v4, s[20:23], s41 offen sc1 lds
    s_mov_b32 m0, 91136
    s_add_u32 s41, s40, 55296
    buffer_load_dwordx4 v4, s[20:23], s41 offen sc1 lds
    s_mov_b32 m0, 92160
    s_add_u32 s41, s40, 88064
    buffer_load_dwordx4 v4, s[20:23], s41 offen sc1 lds
    s_mov_b32 m0, 93184
    s_add_u32 s41, s40, 120832
    buffer_load_dwordx4 v4, s[20:23], s41 offen sc1 lds
    s_mov_b32 m0, 94208
    s_add_u32 s41, s40, 23552
    buffer_load_dwordx4 v4, s[20:23], s41 offen sc1 lds
    s_mov_b32 m0, 95232
    s_add_u32 s41, s40, 56320
    buffer_load_dwordx4 v4, s[20:23], s41 offen sc1 lds
    s_mov_b32 m0, 96256
    s_add_u32 s41, s40, 89088
    buffer_load_dwordx4 v4, s[20:23], s41 offen sc1 lds
    s_mov_b32 m0, 97280
    s_add_u32 s41, s40, 121856
    buffer_load_dwordx4 v4, s[20:23], s41 offen sc1 lds
    s_waitcnt vmcnt(16)
    v_mov_b32 v12, v64
    v_mov_b32 v13, v65
    v_mov_b32 v14, v66
    v_mov_b32 v15, v67
    v_pk_add_f32 v[12:13], v[12:13], v[68:69]
    v_pk_add_f32 v[14:15], v[14:15], v[70:71]
    v_pk_add_f32 v[12:13], v[12:13], v[72:73]
    v_pk_add_f32 v[14:15], v[14:15], v[74:75]
    v_pk_add_f32 v[12:13], v[12:13], v[76:77]
    v_pk_add_f32 v[14:15], v[14:15], v[78:79]
    v_pk_add_f32 v[12:13], v[12:13], v[80:81]
    v_pk_add_f32 v[14:15], v[14:15], v[82:83]
    v_pk_add_f32 v[12:13], v[12:13], v[84:85]
    v_pk_add_f32 v[14:15], v[14:15], v[86:87]
    v_pk_add_f32 v[12:13], v[12:13], v[88:89]
    v_pk_add_f32 v[14:15], v[14:15], v[90:91]
    v_pk_add_f32 v[12:13], v[12:13], v[92:93]
    v_pk_add_f32 v[14:15], v[14:15], v[94:95]
    v_pk_add_f32 v[12:13], v[12:13], v[96:97]
    v_pk_add_f32 v[14:15], v[14:15], v[98:99]
    v_pk_add_f32 v[12:13], v[12:13], v[100:101]
    v_pk_add_f32 v[14:15], v[14:15], v[102:103]
    v_pk_add_f32 v[12:13], v[12:13], v[104:105]
    v_pk_add_f32 v[14:15], v[14:15], v[106:107]
    v_pk_add_f32 v[12:13], v[12:13], v[108:109]
    v_pk_add_f32 v[14:15], v[14:15], v[110:111]
    v_pk_add_f32 v[12:13], v[12:13], v[112:113]
    v_pk_add_f32 v[14:15], v[14:15], v[114:115]
    v_pk_add_f32 v[12:13], v[12:13], v[116:117]
    v_pk_add_f32 v[14:15], v[14:15], v[118:119]
    v_pk_add_f32 v[12:13], v[12:13], v[120:121]
    v_pk_add_f32 v[14:15], v[14:15], v[122:123]
    v_pk_add_f32 v[12:13], v[12:13], v[124:125]
    v_pk_add_f32 v[14:15], v[14:15], v[126:127]
    s_add_u32 s41, s39, 262144
    buffer_load_dwordx4 v[64:67], v4, s[20:23], s41 offen sc1
    s_add_u32 s41, s39, 278528
    buffer_load_dwordx4 v[68:71], v4, s[20:23], s41 offen sc1
    s_add_u32 s41, s39, 294912
    buffer_load_dwordx4 v[72:75], v4, s[20:23], s41 offen sc1
    s_add_u32 s41, s39, 311296
    buffer_load_dwordx4 v[76:79], v4, s[20:23], s41 offen sc1
    s_add_u32 s41, s39, 327680
    buffer_load_dwordx4 v[80:83], v4, s[20:23], s41 offen sc1
    s_add_u32 s41, s39, 344064
    buffer_load_dwordx4 v[84:87], v4, s[20:23], s41 offen sc1
    s_add_u32 s41, s39, 360448
    buffer_load_dwordx4 v[88:91], v4, s[20:23], s41 offen sc1
    s_add_u32 s41, s39, 376832
    buffer_load_dwordx4 v[92:95], v4, s[20:23], s41 offen sc1
    s_add_u32 s41, s39, 393216
    buffer_load_dwordx4 v[96:99], v4, s[20:23], s41 offen sc1
    s_add_u32 s41, s39, 409600
    buffer_load_dwordx4 v[100:103], v4, s[20:23], s41 offen sc1
    s_add_u32 s41, s39, 425984
    buffer_load_dwordx4 v[104:107], v4, s[20:23], s41 offen sc1
    s_add_u32 s41, s39, 442368
    buffer_load_dwordx4 v[108:111], v4, s[20:23], s41 offen sc1
    s_add_u32 s41, s39, 458752
    buffer_load_dwordx4 v[112:115], v4, s[20:23], s41 offen sc1
    s_add_u32 s41, s39, 475136
    buffer_load_dwordx4 v[116:119], v4, s[20:23], s41 offen sc1
    s_add_u32 s41, s39, 491520
    buffer_load_dwordx4 v[120:123], v4, s[20:23], s41 offen sc1
    s_add_u32 s41, s39, 507904
    buffer_load_dwordx4 v[124:127], v4, s[20:23], s41 offen sc1
    s_waitcnt vmcnt(48)
    s_barrier
    s_mov_b32 m0, 98304
    s_add_u32 s41, s40, 24576
    buffer_load_dwordx4 v4, s[20:23], s41 offen sc1 lds
    s_mov_b32 m0, 99328
    s_add_u32 s41, s40, 57344
    buffer_load_dwordx4 v4, s[20:23], s41 offen sc1 lds
    s_mov_b32 m0, 100352
    s_add_u32 s41, s40, 90112
    buffer_load_dwordx4 v4, s[20:23], s41 offen sc1 lds
    s_mov_b32 m0, 101376
    s_add_u32 s41, s40, 122880
    buffer_load_dwordx4 v4, s[20:23], s41 offen sc1 lds
    s_mov_b32 m0, 102400
    s_add_u32 s41, s40, 25600
    buffer_load_dwordx4 v4, s[20:23], s41 offen sc1 lds
    s_mov_b32 m0, 103424
    s_add_u32 s41, s40, 58368
    buffer_load_dwordx4 v4, s[20:23], s41 offen sc1 lds
    s_mov_b32 m0, 104448
    s_add_u32 s41, s40, 91136
    buffer_load_dwordx4 v4, s[20:23], s41 offen sc1 lds
    s_mov_b32 m0, 105472
    s_add_u32 s41, s40, 123904
    buffer_load_dwordx4 v4, s[20:23], s41 offen sc1 lds
    s_mov_b32 m0, 106496
    s_add_u32 s41, s40, 26624
    buffer_load_dwordx4 v4, s[20:23], s41 offen sc1 lds
    s_mov_b32 m0, 107520
    s_add_u32 s41, s40, 59392
    buffer_load_dwordx4 v4, s[20:23], s41 offen sc1 lds
    s_mov_b32 m0, 108544
    s_add_u32 s41, s40, 92160
    buffer_load_dwordx4 v4, s[20:23], s41 offen sc1 lds
    s_mov_b32 m0, 109568
    s_add_u32 s41, s40, 124928
    buffer_load_dwordx4 v4, s[20:23], s41 offen sc1 lds
    s_mov_b32 m0, 110592
    s_add_u32 s41, s40, 27648
    buffer_load_dwordx4 v4, s[20:23], s41 offen sc1 lds
    s_mov_b32 m0, 111616
    s_add_u32 s41, s40, 60416
    buffer_load_dwordx4 v4, s[20:23], s41 offen sc1 lds
    s_mov_b32 m0, 112640
    s_add_u32 s41, s40, 93184
    buffer_load_dwordx4 v4, s[20:23], s41 offen sc1 lds
    s_mov_b32 m0, 113664
    s_add_u32 s41, s40, 125952
    buffer_load_dwordx4 v4, s[20:23], s41 offen sc1 lds
    s_waitcnt vmcnt(16)
    v_pk_add_f32 v[12:13], v[12:13], v[64:65]
    v_pk_add_f32 v[14:15], v[14:15], v[66:67]
    v_pk_add_f32 v[12:13], v[12:13], v[68:69]
    v_pk_add_f32 v[14:15], v[14:15], v[70:71]
    v_pk_add_f32 v[12:13], v[12:13], v[72:73]
    v_pk_add_f32 v[14:15], v[14:15], v[74:75]
    v_pk_add_f32 v[12:13], v[12:13], v[76:77]
    v_pk_add_f32 v[14:15], v[14:15], v[78:79]
    v_pk_add_f32 v[12:13], v[12:13], v[80:81]
    v_pk_add_f32 v[14:15], v[14:15], v[82:83]
    v_pk_add_f32 v[12:13], v[12:13], v[84:85]
    v_pk_add_f32 v[14:15], v[14:15], v[86:87]
    v_pk_add_f32 v[12:13], v[12:13], v[88:89]
    v_pk_add_f32 v[14:15], v[14:15], v[90:91]
    v_pk_add_f32 v[12:13], v[12:13], v[92:93]
    v_pk_add_f32 v[14:15], v[14:15], v[94:95]
    v_pk_add_f32 v[12:13], v[12:13], v[96:97]
    v_pk_add_f32 v[14:15], v[14:15], v[98:99]
    v_pk_add_f32 v[12:13], v[12:13], v[100:101]
    v_pk_add_f32 v[14:15], v[14:15], v[102:103]
    v_pk_add_f32 v[12:13], v[12:13], v[104:105]
    v_pk_add_f32 v[14:15], v[14:15], v[106:107]
    v_pk_add_f32 v[12:13], v[12:13], v[108:109]
    v_pk_add_f32 v[14:15], v[14:15], v[110:111]
    v_pk_add_f32 v[12:13], v[12:13], v[112:113]
    v_pk_add_f32 v[14:15], v[14:15], v[114:115]
    v_pk_add_f32 v[12:13], v[12:13], v[116:117]
    v_pk_add_f32 v[14:15], v[14:15], v[118:119]
    v_pk_add_f32 v[12:13], v[12:13], v[120:121]
    v_pk_add_f32 v[14:15], v[14:15], v[122:123]
    v_pk_add_f32 v[12:13], v[12:13], v[124:125]
    v_pk_add_f32 v[14:15], v[14:15], v[126:127]
    v_mul_f32 v16, 0xbb000000, v12
    v_mul_f32 v2, v16, v16
    v_mov_b32 v3, 0x3b000000
    v_fma_f32 v2, v13, v3, -v2
    v_max_f32 v2, 0, v2
    v_add_f32 v18, 0x3727c5ac, v2
    v_rsq_f32 v2, v18
    s_nop 0
    v_mul_f32 v22, 0xc0135761, v2
    v_mul_f32 v2, v2, v2
    v_mul_f32 v2, v2, v22
    v_mul_f32 v20, 0x3d372713, v2
    v_mov_b32 v17, v16
    v_mov_b32 v19, v18
    v_mov_b32 v21, v20
    v_mov_b32 v23, v22
    v_mul_f32 v24, 0xbb000000, v14
    v_mul_f32 v2, v24, v24
    v_mov_b32 v3, 0x3b000000
    v_fma_f32 v2, v15, v3, -v2
    v_max_f32 v2, 0, v2
    v_add_f32 v26, 0x3727c5ac, v2
    v_rsq_f32 v2, v26
    s_nop 0
    v_mul_f32 v30, 0xc0135761, v2
    v_mul_f32 v2, v2, v2
    v_mul_f32 v2, v2, v30
    v_mul_f32 v28, 0x3d372713, v2
    v_mov_b32 v25, v24
    v_mov_b32 v27, v26
    v_mov_b32 v29, v28
    v_mov_b32 v31, v30
    v_lshlrev_b32 v2, 6, v1
    v_add_u32 v2, 159744, v2
    ds_write_b128 v2, v[16:19] offset:0
    ds_write_b128 v2, v[20:23] offset:16
    ds_write_b128 v2, v[24:27] offset:32
    ds_write_b128 v2, v[28:31] offset:48
    s_waitcnt lgkmcnt(0)
    s_waitcnt vmcnt(32)
    s_barrier
    s_mov_b32 m0, 114688
    s_add_u32 s41, s40, 28672
    buffer_load_dwordx4 v4, s[20:23], s41 offen sc1 lds
    s_mov_b32 m0, 115712
    s_add_u32 s41, s40, 61440
    buffer_load_dwordx4 v4, s[20:23], s41 offen sc1 lds
    s_mov_b32 m0, 116736
    s_add_u32 s41, s40, 94208
    buffer_load_dwordx4 v4, s[20:23], s41 offen sc1 lds
    s_mov_b32 m0, 117760
    s_add_u32 s41, s40, 126976
    buffer_load_dwordx4 v4, s[20:23], s41 offen sc1 lds
    s_mov_b32 m0, 118784
    s_add_u32 s41, s40, 29696
    buffer_load_dwordx4 v4, s[20:23], s41 offen sc1 lds
    s_mov_b32 m0, 119808
    s_add_u32 s41, s40, 62464
    buffer_load_dwordx4 v4, s[20:23], s41 offen sc1 lds
    s_mov_b32 m0, 120832
    s_add_u32 s41, s40, 95232
    buffer_load_dwordx4 v4, s[20:23], s41 offen sc1 lds
    s_mov_b32 m0, 121856
    s_add_u32 s41, s40, 128000
    buffer_load_dwordx4 v4, s[20:23], s41 offen sc1 lds
    s_mov_b32 m0, 122880
    s_add_u32 s41, s40, 30720
    buffer_load_dwordx4 v4, s[20:23], s41 offen sc1 lds
    s_mov_b32 m0, 123904
    s_add_u32 s41, s40, 63488
    buffer_load_dwordx4 v4, s[20:23], s41 offen sc1 lds
    s_mov_b32 m0, 124928
    s_add_u32 s41, s40, 96256
    buffer_load_dwordx4 v4, s[20:23], s41 offen sc1 lds
    s_mov_b32 m0, 125952
    s_add_u32 s41, s40, 129024
    buffer_load_dwordx4 v4, s[20:23], s41 offen sc1 lds
    s_mov_b32 m0, 126976
    s_add_u32 s41, s40, 31744
    buffer_load_dwordx4 v4, s[20:23], s41 offen sc1 lds
    s_mov_b32 m0, 128000
    s_add_u32 s41, s40, 64512
    buffer_load_dwordx4 v4, s[20:23], s41 offen sc1 lds
    s_mov_b32 m0, 129024
    s_add_u32 s41, s40, 97280
    buffer_load_dwordx4 v4, s[20:23], s41 offen sc1 lds
    s_mov_b32 m0, 130048
    s_add_u32 s41, s40, 130048
    buffer_load_dwordx4 v4, s[20:23], s41 offen sc1 lds
    s_waitcnt vmcnt(16)
    s_barrier
    s_waitcnt vmcnt(0)
    s_barrier
    s_lshl_b32 s43, s38, 8
    s_add_u32 s43, s43, 18222080
    v_mov_b32 v5, 140000
    s_mov_b32 s42, 0
f_cnt0:
    s_sleep 1
    ds_read_b32 v24, v5 offset:0
    s_add_u32 s42, s42, 1
    s_waitcnt lgkmcnt(0)
    v_readfirstlane_b32 s41, v24
    s_cmp_gt_u32 s42, 0x100000
    s_cbranch_scc1 f_cnto0
    s_cmp_lt_u32 s41, 7
    s_cbranch_scc1 f_cnt0
f_cnto0:
    s_mov_b32 s42, 0
f_poll1:
    s_sleep 4
    buffer_load_dword v24, v10, s[20:23], s43 offen offset:0 sc1
    s_add_u32 s42, s42, 1
    s_waitcnt vmcnt(0)
    v_cmp_ne_u32 vcc, 1, v24
    s_cmp_gt_u32 s42, 0x40000
    s_cbranch_scc1 f_pout1
    s_cbranch_vccnz f_poll1
f_pout1:
    v_mov_b32 v24, 1
    ds_write_b32 v5, v24 offset:8
    s_mov_b32 s42, 0
f_cnt1:
    s_sleep 1
    ds_read_b32 v24, v5 offset:4
    s_add_u32 s42, s42, 1
    s_waitcnt lgkmcnt(0)
    v_readfirstlane_b32 s41, v24
    s_cmp_gt_u32 s42, 0x100000
    s_cbranch_scc1 f_cnto1
    s_cmp_lt_u32 s41, 7
    s_cbranch_scc1 f_cnt1
f_cnto1:
    s_mov_b32 s42, 0
f_poll2:
    s_sleep 4
    buffer_load_dword v24, v10, s[20:23], s43 offen offset:128 sc1
    s_add_u32 s42, s42, 1
    s_waitcnt vmcnt(0)
    v_cmp_ne_u32 vcc, 1, v24
    s_cmp_gt_u32 s42, 0x40000
    s_cbranch_scc1 f_pout2
    s_cbranch_vccnz f_poll2
f_pout2:
    v_mov_b32 v24, 1
    ds_write_b32 v5, v24 offset:12
f_d_fin:
    s_mov_b32 s42, 0xffff0000
    v_lshlrev_b32 v12, 16, v60
    v_and_b32 v13, s42, v60
    v_lshlrev_b32 v14, 16, v61
    v_and_b32 v15, s42, v61
    v_lshlrev_b32 v16, 16, v62
    v_and_b32 v17, s42, v62
    v_lshlrev_b32 v18, 16, v63
    v_and_b32 v19, s42, v63
    s_mul_i32 s41, s24, 14336
    s_waitcnt lgkmcnt(0)
    s_barrier
    v_add_u32 v2, s41, v4
    ds_read_b128 v[64:67], v2 offset:0
    ds_read_b128 v[68:71], v2 offset:1024
    ds_read_b128 v[72:75], v2 offset:2048
    ds_read_b128 v[76:79], v2 offset:3072
    ds_read_b128 v[80:83], v2 offset:4096
    ds_read_b128 v[84:87], v2 offset:5120
    ds_read_b128 v[88:91], v2 offset:6144
    ds_read_b128 v[92:95], v2 offset:7168
    ds_read_b128 v[96:99], v2 offset:8192
    ds_read_b128 v[100:103], v2 offset:9216
    ds_read_b128 v[104:107], v2 offset:10240
    ds_read_b128 v[108:111], v2 offset:11264
    ds_read_b128 v[112:115], v2 offset:12288
    ds_read_b128 v[116:119], v2 offset:13312
    s_waitcnt lgkmcnt(10)
    v_pk_add_f32 v[64:65], v[64:65], v[72:73]
    v_pk_add_f32 v[66:67], v[66:67], v[74:75]
    v_pk_add_f32 v[68:69], v[68:69], v[76:77]
    v_pk_add_f32 v[70:71], v[70:71], v[78:79]
    s_waitcnt lgkmcnt(8)
    v_pk_add_f32 v[64:65], v[64:65], v[80:81]
    v_pk_add_f32 v[66:67], v[66:67], v[82:83]
    v_pk_add_f32 v[68:69], v[68:69], v[84:85]
    v_pk_add_f32 v[70:71], v[70:71], v[86:87]
    s_waitcnt lgkmcnt(6)
    v_pk_add_f32 v[64:65], v[64:65], v[88:89]
    v_pk_add_f32 v[66:67], v[66:67], v[90:91]
    v_pk_add_f32 v[68:69], v[68:69], v[92:93]
    v_pk_add_f32 v[70:71], v[70:71], v[94:95]
    s_waitcnt lgkmcnt(4)
    v_pk_add_f32 v[64:65], v[64:65], v[96:97]
    v_pk_add_f32 v[66:67], v[66:67], v[98:99]
    v_pk_add_f32 v[68:69], v[68:69], v[100:101]
    v_pk_add_f32 v[70:71], v[70:71], v[102:103]
    s_waitcnt lgkmcnt(2)
    v_pk_add_f32 v[64:65], v[64:65], v[104:105]
    v_pk_add_f32 v[66:67], v[66:67], v[106:107]
    v_pk_add_f32 v[68:69], v[68:69], v[108:109]
    v_pk_add_f32 v[70:71], v[70:71], v[110:111]
    s_waitcnt lgkmcnt(0)
    v_pk_add_f32 v[64:65], v[64:65], v[112:113]
    v_pk_add_f32 v[66:67], v[66:67], v[114:115]
    v_pk_add_f32 v[68:69], v[68:69], v[116:117]
    v_pk_add_f32 v[70:71], v[70:71], v[118:119]
    v_pk_add_f32 v[12:13], v[12:13], v[64:65]
    v_pk_add_f32 v[14:15], v[14:15], v[66:67]
    v_pk_add_f32 v[16:17], v[16:17], v[68:69]
    v_pk_add_f32 v[18:19], v[18:19], v[70:71]
    v_cvt_pk_bf16_f32 v20, v12, v13
    v_cvt_pk_bf16_f32 v21, v14, v15
    v_cvt_pk_bf16_f32 v22, v16, v17
    v_cvt_pk_bf16_f32 v23, v18, v19
    s_nop 0
    v_permlane32_swap_b32 v20, v22
    v_permlane32_swap_b32 v21, v23
    buffer_store_dwordx4 v[20:23], v7, s[16:19], s63 offen
f_end:
    s_endpgm
.section .rodata,"a"
.p2align 6
.amdhsa_kernel qkv_kernel
  .amdhsa_next_free_vgpr 124
  .amdhsa_next_free_sgpr 46
  .amdhsa_accum_offset 124
  .amdhsa_group_segment_fixed_size 0
  .amdhsa_kernarg_size 80
  .amdhsa_user_sgpr_count 2
  .amdhsa_user_sgpr_kernarg_segment_ptr 1
  .amdhsa_system_sgpr_workgroup_id_x 1
.end_amdhsa_kernel
.p2align 6
.amdhsa_kernel fused_kernel
  .amdhsa_next_free_vgpr 256
  .amdhsa_next_free_sgpr 64
  .amdhsa_accum_offset 128
  .amdhsa_group_segment_fixed_size 0
  .amdhsa_kernarg_size 80
  .amdhsa_user_sgpr_count 2
  .amdhsa_user_sgpr_kernarg_segment_ptr 1
  .amdhsa_system_sgpr_workgroup_id_x 1
.end_amdhsa_kernel
```
